```python
import torch

def _softmax(x, axis=-1):
    return torch.softmax(x, dim=axis)
def _gelu(x):
    return torch.nn.functional.gelu(x, approximate="tanh")
def _silu(x):
    return torch.nn.functional.silu(x)
def _sigmoid(x):
    return torch.sigmoid(x)
def _layernorm(x, axis=-1, eps=1e-5):
    m = x.mean(dim=axis, keepdim=True)
    v = x.var(dim=axis, keepdim=True, unbiased=False)
    return (x - m) / torch.sqrt(v + eps)
def _scatter_add(tgt, idx, src, axis=0):
    return tgt.clone().index_add_(axis, idx, src)
def _segment_sum(src, seg, n):
    out = torch.zeros((n,) + src.shape[1:], dtype=src.dtype)
    return out.index_add_(0, seg, src)
def _pad(x, pw):
    flat = tuple(v for pair in reversed(pw) for v in pair)
    return torch.nn.functional.pad(x, flat)

kernel_name = 'interleave_layers__spectral_fnet__moe_arch_mod__prompt'

def setup_inputs():

    _w = (lambda a: (lambda t: t.to(torch.bfloat16) if t.is_floating_point() else t)(torch.as_tensor(a)))
    def _A_setup():
        B, S, D = 1, 2048, 512
        ns = torch.arange(S)[:, None] * torch.arange(S)[None, :]
        nd = torch.arange(D)[:, None] * torch.arange(D)[None, :]
        Ws_re = torch.cos(-2.0 * torch.pi * ns / S).to(float)
        Ws_im = torch.sin(-2.0 * torch.pi * ns / S).to(float)
        Wd_re = torch.cos(-2.0 * torch.pi * nd / D).to(float)
        Wd_im = torch.sin(-2.0 * torch.pi * nd / D).to(float)
        return {
            "x": _w((lambda *s: torch.randn(*s, dtype=torch.bfloat16) * 0.05)(B, S, D)),
            "dft_seq_re": _w(Ws_re),
            "dft_seq_im": _w(Ws_im),
            "dft_hid_re": _w(Wd_re),
            "dft_hid_im": _w(Wd_im),
        }
    _A_in = _A_setup()

    def _B_setup():
        B, S, D, F, C = 1, 2048, 512, 1376, 1
        return {
            "x": _w((lambda *s: torch.randn(*s, dtype=torch.bfloat16) * 0.05)(B, S, D)),
            "w_r": _w((lambda *s: torch.randn(*s, dtype=torch.bfloat16) * 1.6)(D)),
            "w_gate": _w((lambda *s: torch.randn(*s, dtype=torch.bfloat16) * 0.4)(D, F)),
            "w_up": _w((lambda *s: torch.randn(*s, dtype=torch.bfloat16) * 0.4)(D, F)),
            "w_down": _w((lambda *s: torch.randn(*s, dtype=torch.bfloat16) * 0.4)(F, D)),
        }
    _B_in = _B_setup()

    return {
        "A_x": _A_in["x"],
        "A_dft_seq_re": _A_in["dft_seq_re"],
        "A_dft_seq_im": _A_in["dft_seq_im"],
        "A_dft_hid_re": _A_in["dft_hid_re"],
        "A_dft_hid_im": _A_in["dft_hid_im"],
        "B_x": _B_in["x"],
        "B_w_r": _B_in["w_r"],
        "B_w_gate": _B_in["w_gate"],
        "B_w_up": _B_in["w_up"],
        "B_w_down": _B_in["w_down"],
    }

def reference(A_x, A_dft_seq_re, A_dft_seq_im, A_dft_hid_re, A_dft_hid_im, B_x, B_w_r, B_w_gate, B_w_up, B_w_down):
    def _A_ref(x, dft_seq_re, dft_seq_im, dft_hid_re, dft_hid_im):
        a = torch.einsum("bsd,ed->bse", x, dft_hid_re)
        b = torch.einsum("bsd,ed->bse", x, dft_hid_im)
        y = torch.einsum("ts,bse->bte", dft_seq_re, a) - torch.einsum("ts,bse->bte", dft_seq_im, b)
        return y

    def _B_ref(x, w_r, w_gate, w_up, w_down):
        B, S, D = x.shape
        C = 1
        r = x @ w_r
        idx = torch.argsort(-r, axis=-1)[:, :C]
        idx_e = (lambda x, n, axis: torch.repeat_interleave(x, n, dim=axis))(idx.reshape(B, C, 1), D, axis=2)
        x_sel = (lambda x, i, axis: torch.take_along_dim(x, i, dim=axis))(x, idx_e, axis=1)
        g = _silu(x_sel @ w_gate)
        u = x_sel @ w_up
        y = (g * u) @ w_down
        r_sel = _sigmoid((lambda x, i, axis: torch.take_along_dim(x, i, dim=axis))(r, idx, axis=1))
        y = y * r_sel.reshape(B, C, 1)
        b_off = (torch.arange(B) * S).reshape(B, 1)
        flat_idx = (idx + b_off).reshape(B * C)
        zero = (x * 0.0).reshape(B * S, D)
        upd = _scatter_add(zero, flat_idx, y.reshape(B * C, D), axis=0)
        return x + upd.reshape(B, S, D)

    x = A_x
    x = x + _A_ref(_layernorm(x, axis=-1), A_dft_seq_re, A_dft_seq_im, A_dft_hid_re, A_dft_hid_im)
    x = x + _B_ref(_layernorm(x, axis=-1), B_w_r, B_w_gate, B_w_up, B_w_down)
    x = x + _A_ref(_layernorm(x, axis=-1), A_dft_seq_re, A_dft_seq_im, A_dft_hid_re, A_dft_hid_im)
    x = x + _B_ref(_layernorm(x, axis=-1), B_w_r, B_w_gate, B_w_up, B_w_down)
    return x
```

```asm
; @launch grid=(256,1,1) block=(320,1,1) lds=52352
.amdgcn_target "amdgcn-amd-amdhsa--gfx950"
.text
.globl interleave_layers__spectral_fnet__moe_arch_mod__prompt_kernel
.p2align 8
.type interleave_layers__spectral_fnet__moe_arch_mod__prompt_kernel,@function
interleave_layers__spectral_fnet__moe_arch_mod__prompt_kernel:
    s_cmp_ge_u32 s2, 256
    s_cbranch_scc1 L_done
    s_load_dwordx16 s[72:87], s[0:1], 0
    s_load_dwordx8 s[88:95], s[0:1], 64
    s_load_dwordx2 s[96:97], s[0:1], 96
    s_getpc_b64 s[64:65]
L_pc:
    v_lshlrev_b32 v208, 7, v0
    v_min_u32 v208, L_code_end-L_pc-4, v208
    global_load_dword v185, v208, s[64:65]
    s_add_u32 s64, s64, L_tab-L_pc
    s_addc_u32 s65, s65, 0
    s_mov_b32 s33, s2
    s_and_b32 s27, s2, 7
    s_lshl_b32 s27, s27, 5
    s_lshr_b32 s20, s2, 3
    s_or_b32 s20, s20, s27
    v_lshrrev_b32 v209, 6, v0
    v_and_b32 v1, 63, v0
    v_readfirstlane_b32 s21, v209
    v_lshlrev_b32 v210, 4, v1
    v_sub_u32 v211, 1008, v210
    s_lshl_b32 s27, s20, 2
    s_add_u32 s22, s27, s21
    s_sub_u32 s23, 2048, s22
    s_cmp_eq_u32 s22, 0
    s_cselect_b32 s23, 1024, s23
    s_lshl_b32 s27, s22, 10
    s_lshl_b32 s28, s23, 10
    v_add_u32 v176, s27, v210
    v_add_u32 v177, s28, v211
    v_lshlrev_b32 v183, 4, v0
    s_waitcnt lgkmcnt(0)
    s_sub_u32 s68, s20, 1
    s_cmp_eq_u32 s21, 4
    s_cbranch_scc1 L_loader
    s_mov_b32 s8, s72
    s_mov_b32 s9, s73
    s_mov_b32 s10, 2097152
    s_mov_b32 s11, 0x00020000
    buffer_load_dwordx4 v[216:219], v176, s[8:11], 0 offen
    buffer_load_dwordx4 v[220:223], v177, s[8:11], 0 offen
    s_mov_b32 s4, s96
    s_mov_b32 s5, s97
    s_mov_b32 s6, 10485760
    s_mov_b32 s7, 0x00020000
    v_mov_b32 v187, 0
    buffer_load_dword v187, v187, s[4:7], 0 offen
    v_mov_b32 v248, -1
    v_mov_b32 v249, -1
    v_mov_b32 v250, -1
    v_mov_b32 v251, -1
    s_lshl_b32 s27, s20, 12
    v_add_u32 v178, s27, v183
    s_mov_b32 s25, 3145728
    buffer_store_dwordx4 v[248:251], v178, s[4:7], s25 offen sc1
    s_mov_b32 s25, 4194304
    buffer_store_dwordx4 v[248:251], v178, s[4:7], s25 offen sc1
    s_mov_b32 s25, 6291456
    buffer_store_dwordx4 v[248:251], v178, s[4:7], s25 offen sc1
    s_cmp_lg_u32 s22, 0
    s_cbranch_scc1 L_nokb_1
    v_lshlrev_b32 v213, 4, v1
    s_mov_b32 s25, 9441280
    buffer_store_dwordx4 v[248:251], v213, s[4:7], s25 offen sc1
    s_mov_b32 s25, 9445376
    buffer_store_dwordx4 v[248:251], v213, s[4:7], s25 offen sc1
L_nokb_1:
    s_mov_b32 s12, s92
    s_mov_b32 s13, s93
    s_mov_b32 s14, 2097152
    s_mov_b32 s15, 0x00020000
    s_mov_b32 s30, 0x41800000
    v_and_b32 v2, 15, v1
    v_lshrrev_b32 v3, 4, v1
    s_lshl_b32 s27, s21, 10
    v_lshlrev_b32 v230, 4, v1
    v_add_u32 v160, s27, v230
    s_add_u32 s28, s27, 10224
    v_sub_u32 v162, s28, v230
    v_lshrrev_b32 v231, 2, v2
    v_lshl_add_u32 v230, v3, 3, v231
    v_lshlrev_b32 v230, 5, v230
    v_and_b32 v231, 3, v2
    v_lshl_add_u32 v230, v231, 3, v230
    v_add_u32 v161, s27, v230
    v_lshrrev_b32 v231, 3, v2
    v_add_u32 v231, v231, v2
    v_lshlrev_b32 v231, 4, v231
    v_mul_u32_u24 v232, 272, v3
    v_add_u32 v163, v231, v232
    v_add_u32 v163, 17472, v163
    s_sub_u32 s29, 4, s21
    s_and_b32 s29, s29, 3
    s_add_u32 s29, s29, 4
    s_lshl_b32 s29, s29, 1
    s_lshl_b32 s28, s21, 1
    v_lshlrev_b32 v228, 7, v3
    v_add_u32 v229, v228, v2
    v_sub_u32 v230, v228, v2
    v_and_b32 v231, 8, v229
    v_and_b32 v232, 8, v230
    v_xor_b32 v231, s28, v231
    v_xor_b32 v232, s29, v232
    v_lshl_add_u32 v229, v229, 4, v231
    v_lshl_add_u32 v230, v230, 4, v232
    v_add_u32 v229, 13312, v229
    v_add_u32 v230, 9728, v230
    v_cmp_gt_u32 vcc, 2, v3
    v_add_u32 v231, 256, v229
    v_subrev_u32 v232, 256, v230
    v_cndmask_b32 v164, v230, v229, vcc
    v_cndmask_b32 v165, v232, v231, vcc
    s_add_u32 s28, s28, 13312
    s_add_u32 s29, s29, 13312
    v_mov_b32 v228, 17424
    v_mov_b32 v229, s28
    v_mov_b32 v230, s29
    v_cmp_eq_u32 vcc, 48, v1
    s_nop 1
    v_cndmask_b32 v166, v228, v229, vcc
    v_cndmask_b32 v167, v228, v230, vcc
    v_cvt_f32_u32 v240, v3
    v_cvt_f32_u32 v241, v2
    v_mul_f32 v242, 0x3d000000, v241
    v_mul_f32 v244, 0x41000000, v240
    v_mul_f32 v243, v244, v242
    v_cos_f32 v238, v243
    v_add_f32 v243, v243, v242
    v_cos_f32 v239, v243
    v_add_f32 v243, v243, v242
    v_cvt_pk_f16_f32 v36, v238, v239
    v_cos_f32 v238, v243
    v_add_f32 v243, v243, v242
    v_cos_f32 v239, v243
    v_add_f32 v243, v243, v242
    v_cvt_pk_f16_f32 v37, v238, v239
    v_cos_f32 v238, v243
    v_add_f32 v243, v243, v242
    v_cos_f32 v239, v243
    v_add_f32 v243, v243, v242
    v_cvt_pk_f16_f32 v38, v238, v239
    v_cos_f32 v238, v243
    v_add_f32 v243, v243, v242
    v_cos_f32 v239, v243
    s_nop 0
    v_cvt_pk_f16_f32 v39, v238, v239
    v_mul_f32 v243, v244, v242
    v_add_f32 v243, 0x3e800000, v243
    v_cos_f32 v238, v243
    v_add_f32 v243, v243, v242
    v_cos_f32 v239, v243
    v_add_f32 v243, v243, v242
    v_cvt_pk_f16_f32 v40, v238, v239
    v_cos_f32 v238, v243
    v_add_f32 v243, v243, v242
    v_cos_f32 v239, v243
    v_add_f32 v243, v243, v242
    v_cvt_pk_f16_f32 v41, v238, v239
    v_cos_f32 v238, v243
    v_add_f32 v243, v243, v242
    v_cos_f32 v239, v243
    v_add_f32 v243, v243, v242
    v_cvt_pk_f16_f32 v42, v238, v239
    v_cos_f32 v238, v243
    v_add_f32 v243, v243, v242
    v_cos_f32 v239, v243
    s_nop 0
    v_cvt_pk_f16_f32 v43, v238, v239
    v_xor_b32 v44, 0x80000000, v36
    v_xor_b32 v45, 0x80000000, v37
    v_xor_b32 v46, 0x80000000, v38
    v_xor_b32 v47, 0x80000000, v39
    v_xor_b32 v48, 0x80000000, v40
    v_xor_b32 v49, 0x80000000, v41
    v_xor_b32 v50, 0x80000000, v42
    v_xor_b32 v51, 0x80000000, v43
    v_mul_f32 v244, 4.0, v240
    v_add_f32 v242, 0x00000000, v241
    v_mul_f32 v242, 0x3b000000, v242
    v_mul_f32 v243, v244, v242
    v_cos_f32 v52, v243
    v_sin_f32 v60, v243
    v_add_f32 v243, v243, v242
    v_cos_f32 v53, v243
    v_sin_f32 v61, v243
    v_add_f32 v243, v243, v242
    v_cos_f32 v54, v243
    v_sin_f32 v62, v243
    v_add_f32 v243, v243, v242
    v_cos_f32 v55, v243
    v_sin_f32 v63, v243
    v_add_f32 v242, 0x41800000, v241
    v_mul_f32 v242, 0x3b000000, v242
    v_mul_f32 v243, v244, v242
    v_cos_f32 v56, v243
    v_sin_f32 v64, v243
    v_add_f32 v243, v243, v242
    v_cos_f32 v57, v243
    v_sin_f32 v65, v243
    v_add_f32 v243, v243, v242
    v_cos_f32 v58, v243
    v_sin_f32 v66, v243
    v_add_f32 v243, v243, v242
    v_cos_f32 v59, v243
    v_sin_f32 v67, v243
    v_sub_u32 v242, 23, v2
    v_cmp_gt_u32 vcc, 8, v2
    s_nop 1
    v_cndmask_b32 v242, v242, v2, vcc
    v_cvt_f32_u32 v242, v242
    v_mul_f32 v242, 0x3d800000, v242
    v_mul_f32 v245, v244, v242
    v_add_f32 v243, 0x3e000000, v245
    v_cos_f32 v238, v243
    v_add_f32 v243, v243, v242
    v_cos_f32 v239, v243
    v_add_f32 v243, v243, v242
    v_mul_f32 v238, 0x3fb504f3, v238
    v_mul_f32 v239, 0x3fb504f3, v239
    v_cvt_pk_f16_f32 v68, v238, v239
    v_cos_f32 v238, v243
    v_add_f32 v243, v243, v242
    v_cos_f32 v239, v243
    v_mul_f32 v238, 0x3fb504f3, v238
    v_mul_f32 v239, 0x3fb504f3, v239
    v_cvt_pk_f16_f32 v69, v238, v239
    v_add_f32 v243, 0xbe000000, v245
    v_cos_f32 v238, v243
    v_add_f32 v243, v243, v242
    v_cos_f32 v239, v243
    v_add_f32 v243, v243, v242
    v_mul_f32 v238, 0x3fb504f3, v238
    v_mul_f32 v239, 0x3fb504f3, v239
    v_cvt_pk_f16_f32 v70, v238, v239
    v_cos_f32 v238, v243
    v_add_f32 v243, v243, v242
    v_cos_f32 v239, v243
    v_mul_f32 v238, 0x3fb504f3, v238
    v_mul_f32 v239, 0x3fb504f3, v239
    v_cvt_pk_f16_f32 v71, v238, v239
    s_waitcnt vmcnt(3)
    v_readfirstlane_b32 s53, v187
    s_nop 0
    s_mul_i32 s53, s53, 0x9e3779b1
    s_add_u32 s53, s53, 0x7f4a7c15
    v_lshlrev_b32 v4, 16, v216
    v_and_b32 v5, 0xffff0000, v216
    v_lshlrev_b32 v6, 16, v217
    v_and_b32 v7, 0xffff0000, v217
    v_lshlrev_b32 v8, 16, v218
    v_and_b32 v9, 0xffff0000, v218
    v_lshlrev_b32 v10, 16, v219
    v_and_b32 v11, 0xffff0000, v219
    v_lshlrev_b32 v224, 16, v220
    v_and_b32 v19, 0xffff0000, v220
    v_lshlrev_b32 v18, 16, v221
    v_and_b32 v17, 0xffff0000, v221
    v_mov_b32_dpp v12, v224 wave_ror:1 row_mask:0xf bank_mask:0xf
    v_lshlrev_b32 v16, 16, v222
    v_and_b32 v15, 0xffff0000, v222
    v_lshlrev_b32 v14, 16, v223
    v_and_b32 v13, 0xffff0000, v223
    v_readfirstlane_b32 s36, v4
    v_readfirstlane_b32 s38, v12
    s_nop 0
    v_pk_add_f32 v[208:209], v[4:5], s[36:37] op_sel_hi:[1,0] neg_lo:[0,1] neg_hi:[0,1]
    v_pk_add_f32 v[210:211], v[6:7], s[36:37] op_sel_hi:[1,0] neg_lo:[0,1] neg_hi:[0,1]
    v_pk_add_f32 v[212:213], v[8:9], s[36:37] op_sel_hi:[1,0] neg_lo:[0,1] neg_hi:[0,1]
    v_pk_add_f32 v[214:215], v[10:11], s[36:37] op_sel_hi:[1,0] neg_lo:[0,1] neg_hi:[0,1]
    v_pk_add_f32 v[232:233], v[208:209], v[210:211]
    v_pk_mul_f32 v[234:235], v[208:209], v[208:209]
    v_pk_add_f32 v[236:237], v[212:213], v[214:215]
    v_pk_fma_f32 v[234:235], v[210:211], v[210:211], v[234:235]
    v_pk_add_f32 v[232:233], v[232:233], v[236:237]
    v_pk_fma_f32 v[234:235], v[212:213], v[212:213], v[234:235]
    v_pk_fma_f32 v[234:235], v[214:215], v[214:215], v[234:235]
    v_add_f32 v224, v232, v233
    v_add_f32 v225, v234, v235
    v_pk_add_f32 v[216:217], v[12:13], s[38:39] op_sel_hi:[1,0] neg_lo:[0,1] neg_hi:[0,1]
    v_pk_add_f32 v[218:219], v[14:15], s[38:39] op_sel_hi:[1,0] neg_lo:[0,1] neg_hi:[0,1]
    v_pk_add_f32 v[220:221], v[16:17], s[38:39] op_sel_hi:[1,0] neg_lo:[0,1] neg_hi:[0,1]
    v_pk_add_f32 v[222:223], v[18:19], s[38:39] op_sel_hi:[1,0] neg_lo:[0,1] neg_hi:[0,1]
    v_pk_add_f32 v[240:241], v[216:217], v[218:219]
    v_pk_mul_f32 v[242:243], v[216:217], v[216:217]
    v_pk_add_f32 v[244:245], v[220:221], v[222:223]
    v_pk_fma_f32 v[242:243], v[218:219], v[218:219], v[242:243]
    v_pk_add_f32 v[240:241], v[240:241], v[244:245]
    v_pk_fma_f32 v[242:243], v[220:221], v[220:221], v[242:243]
    v_pk_fma_f32 v[242:243], v[222:223], v[222:223], v[242:243]
    v_add_f32 v227, v240, v241
    v_add_f32 v228, v242, v243
    s_nop 0
    v_permlane32_swap_b32 v224, v227
    v_permlane32_swap_b32 v225, v228
    v_add_f32 v224, v224, v227
    v_add_f32 v225, v225, v228
    s_nop 0
    v_add_f32_dpp v224, v224, v224 row_ror:8 row_mask:0xf bank_mask:0xf
    v_add_f32_dpp v225, v225, v225 row_ror:8 row_mask:0xf bank_mask:0xf
    s_nop 0
    v_add_f32_dpp v224, v224, v224 row_ror:4 row_mask:0xf bank_mask:0xf
    v_add_f32_dpp v225, v225, v225 row_ror:4 row_mask:0xf bank_mask:0xf
    s_nop 0
    v_add_f32_dpp v224, v224, v224 row_ror:2 row_mask:0xf bank_mask:0xf
    v_add_f32_dpp v225, v225, v225 row_ror:2 row_mask:0xf bank_mask:0xf
    s_nop 0
    v_add_f32_dpp v224, v224, v224 row_ror:1 row_mask:0xf bank_mask:0xf
    v_add_f32_dpp v225, v225, v225 row_ror:1 row_mask:0xf bank_mask:0xf
    v_mov_b32 v227, v224
    v_mov_b32 v228, v225
    s_nop 0
    v_permlane16_swap_b32 v224, v227
    v_permlane16_swap_b32 v225, v228
    v_add_f32 v224, v224, v227
    v_add_f32 v225, v225, v228
    v_mul_f32 v248, 0x3b000000, v224
    v_mul_f32 v225, 0x3b000000, v225
    v_fma_f32 v249, -v248, v248, v225
    v_add_f32 v225, 0x3727c5ac, v249
    v_rsq_f32 v250, v225
    s_nop 0
    v_mul_f32 v251, -v248, v250
    v_readlane_b32 s46, v250, 0
    v_readlane_b32 s47, v251, 0
    v_readlane_b32 s48, v250, 32
    v_readlane_b32 s49, v251, 32
    v_pk_fma_f32 v[224:225], v[208:209], s[46:47], s[46:47] op_sel:[0,0,1] op_sel_hi:[1,0,1]
    v_pk_fma_f32 v[226:227], v[210:211], s[46:47], s[46:47] op_sel:[0,0,1] op_sel_hi:[1,0,1]
    v_pk_fma_f32 v[228:229], v[212:213], s[46:47], s[46:47] op_sel:[0,0,1] op_sel_hi:[1,0,1]
    v_pk_fma_f32 v[230:231], v[214:215], s[46:47], s[46:47] op_sel:[0,0,1] op_sel_hi:[1,0,1]
    v_pk_fma_f32 v[224:225], v[216:217], s[48:49], v[224:225] op_sel_hi:[1,0,1]
    v_pk_fma_f32 v[226:227], v[218:219], s[48:49], v[226:227] op_sel_hi:[1,0,1]
    v_pk_fma_f32 v[228:229], v[220:221], s[48:49], v[228:229] op_sel_hi:[1,0,1]
    v_pk_fma_f32 v[230:231], v[222:223], s[48:49], v[230:231] op_sel_hi:[1,0,1]
    s_waitcnt vmcnt(3)
    v_cvt_pk_f16_f32 v232, v224, v225
    v_cvt_pk_f16_f32 v233, v226, v227
    v_cvt_pk_f16_f32 v234, v228, v229
    v_cvt_pk_f16_f32 v235, v230, v231
    ds_write_b128 v160, v[232:235] offset:5120
    ds_read_b64_tr_b16 v[240:241], v161 offset:5120
    ds_read_b64_tr_b16 v[242:243], v161 offset:5248
    s_waitcnt lgkmcnt(0)
    v_mfma_f32_16x16x32_f16 v[208:211], v[240:243], v[36:39], 0
    v_mfma_f32_16x16x32_f16 v[212:215], v[240:243], v[40:43], 0
    v_mfma_f32_16x16x32_f16 v[216:219], v[240:243], v[44:47], 0
    v_mfma_f32_16x16x32_f16 v[220:223], v[240:243], v[48:51], 0
    s_nop 4
    v_pk_mul_f32 v[232:233], v[208:209], v[52:53]
    v_pk_mul_f32 v[236:237], v[212:213], v[52:53]
    v_pk_fma_f32 v[232:233], v[212:213], v[60:61], v[232:233]
    v_pk_fma_f32 v[236:237], v[208:209], v[60:61], v[236:237] neg_lo:[1,0,0] neg_hi:[1,0,0]
    v_pk_mul_f32 v[234:235], v[210:211], v[54:55]
    v_pk_mul_f32 v[238:239], v[214:215], v[54:55]
    v_pk_fma_f32 v[234:235], v[214:215], v[62:63], v[234:235]
    v_pk_fma_f32 v[238:239], v[210:211], v[62:63], v[238:239] neg_lo:[1,0,0] neg_hi:[1,0,0]
    v_cvt_pk_f16_f32 v224, v232, v233
    v_cvt_pk_f16_f32 v225, v234, v235
    v_cvt_pk_f16_f32 v226, v236, v237
    v_cvt_pk_f16_f32 v227, v238, v239
    s_nop 1
    v_mfma_f32_16x16x32_f16 v[244:247], v[68:71], v[224:227], 0
    v_pk_mul_f32 v[232:233], v[216:217], v[56:57]
    v_pk_mul_f32 v[236:237], v[220:221], v[56:57]
    v_pk_fma_f32 v[232:233], v[220:221], v[64:65], v[232:233]
    v_pk_fma_f32 v[236:237], v[216:217], v[64:65], v[236:237] neg_lo:[1,0,0] neg_hi:[1,0,0]
    v_pk_mul_f32 v[234:235], v[218:219], v[58:59]
    v_pk_mul_f32 v[238:239], v[222:223], v[58:59]
    v_pk_fma_f32 v[234:235], v[222:223], v[66:67], v[234:235]
    v_pk_fma_f32 v[238:239], v[218:219], v[66:67], v[238:239] neg_lo:[1,0,0] neg_hi:[1,0,0]
    v_cvt_pk_f16_f32 v228, v232, v233
    v_cvt_pk_f16_f32 v229, v234, v235
    v_cvt_pk_f16_f32 v230, v236, v237
    v_cvt_pk_f16_f32 v231, v238, v239
    s_nop 1
    v_mfma_f32_16x16x32_f16 v[248:251], v[68:71], v[228:231], 0
    v_cvt_pk_f16_f32 v252, v244, v245
    v_cvt_pk_f16_f32 v253, v246, v247
    s_nop 5
    v_cvt_pk_f16_f32 v254, v248, v249
    v_cvt_pk_f16_f32 v255, v250, v251
    ds_write_b16 v164, v252 offset:0
    ds_write_b16_d16_hi v164, v252 offset:512
    ds_write_b16 v164, v253 offset:1024
    ds_write_b16_d16_hi v164, v253 offset:1536
    ds_write_b16 v165, v254 offset:0
    ds_write_b16_d16_hi v165, v254 offset:512
    ds_write_b16 v165, v255 offset:1024
    ds_write_b16_d16_hi v165, v255 offset:1536
    ds_write_b16_d16_hi v166, v253
    ds_write_b16_d16_hi v167, v253
    v_lshlrev_b32 v216, 3, v0
    s_lshl_b32 s27, s20, 13
    v_add_u32 v217, s27, v183
    v_mov_b32 v209, s53
    v_mov_b32 v211, s53
    v_mov_b32 v213, s53
    v_mov_b32 v215, s53
    s_waitcnt vmcnt(0)
    s_waitcnt lgkmcnt(0)
    s_barrier
    ds_read_b32 v208, v216 offset:13312
    ds_read_b32 v210, v216 offset:13316
    ds_read_b32 v212, v216 offset:15360
    ds_read_b32 v214, v216 offset:15364
    s_mov_b32 s25, 1048576
    s_mov_b32 s27, 1052672
    s_waitcnt lgkmcnt(2)
    buffer_store_dwordx4 v[208:211], v217, s[4:7], s25 offen sc1
    s_waitcnt lgkmcnt(0)
    buffer_store_dwordx4 v[212:215], v217, s[4:7], s27 offen sc1
    s_cmp_lg_u32 s22, 0
    s_cbranch_scc1 L_nok_2
    v_mov_b32 v252, s46
    v_mov_b32 v253, s47
    v_fma_f32 v253, -v252, s36, v253
    v_readfirstlane_b32 s54, v252
    v_readfirstlane_b32 s55, v253
    v_mov_b32 v252, s48
    v_mov_b32 v253, s49
    v_fma_f32 v253, -v252, s38, v253
    v_readfirstlane_b32 s56, v252
    v_readfirstlane_b32 s57, v253
    v_pk_fma_f32 v[208:209], v[4:5], s[54:55], s[54:55] op_sel:[0,0,1] op_sel_hi:[1,0,1]
    v_pk_fma_f32 v[210:211], v[6:7], s[54:55], s[54:55] op_sel:[0,0,1] op_sel_hi:[1,0,1]
    v_pk_fma_f32 v[212:213], v[8:9], s[54:55], s[54:55] op_sel:[0,0,1] op_sel_hi:[1,0,1]
    v_pk_fma_f32 v[214:215], v[10:11], s[54:55], s[54:55] op_sel:[0,0,1] op_sel_hi:[1,0,1]
    v_pk_fma_f32 v[216:217], v[12:13], s[56:57], s[56:57] op_sel:[0,0,1] op_sel_hi:[1,0,1]
    v_pk_fma_f32 v[218:219], v[14:15], s[56:57], s[56:57] op_sel:[0,0,1] op_sel_hi:[1,0,1]
    v_pk_fma_f32 v[220:221], v[16:17], s[56:57], s[56:57] op_sel:[0,0,1] op_sel_hi:[1,0,1]
    v_pk_fma_f32 v[222:223], v[18:19], s[56:57], s[56:57] op_sel:[0,0,1] op_sel_hi:[1,0,1]
    v_mov_b32_dpp v228, v208 wave_rol:1 row_mask:0xf bank_mask:0xf
    v_cvt_pk_f16_f32 v225, v214, v213
    v_cvt_pk_f16_f32 v226, v212, v211
    v_cvt_pk_f16_f32 v227, v210, v209
    v_cvt_pk_f16_f32 v224, v228, v215
    ds_write_b128 v162, v[224:227]
    v_cvt_pk_f16_f32 v232, v216, v217
    v_cvt_pk_f16_f32 v233, v218, v219
    v_cvt_pk_f16_f32 v234, v220, v221
    v_cvt_pk_f16_f32 v235, v222, v223
    ds_write_b128 v160, v[232:235] offset:5120
    ds_read_b64_tr_b16 v[240:241], v161 offset:9216
    ds_read_b64_tr_b16 v[248:249], v161 offset:5120
    ds_read_b64_tr_b16 v[242:243], v161 offset:9344
    ds_read_b64_tr_b16 v[250:251], v161 offset:5248
    s_waitcnt lgkmcnt(0)
    v_pk_add_f16 v240, v240, v248 neg_lo:[0,1] neg_hi:[0,1]
    v_pk_add_f16 v241, v241, v249 neg_lo:[0,1] neg_hi:[0,1]
    v_pk_add_f16 v242, v242, v250 neg_lo:[0,1] neg_hi:[0,1]
    v_pk_add_f16 v243, v243, v251 neg_lo:[0,1] neg_hi:[0,1]
    s_nop 1
    v_mfma_f32_16x16x32_f16 v[208:211], v[240:243], v[36:39], 0
    v_mfma_f32_16x16x32_f16 v[212:215], v[240:243], v[40:43], 0
    v_mfma_f32_16x16x32_f16 v[216:219], v[240:243], v[44:47], 0
    v_mfma_f32_16x16x32_f16 v[220:223], v[240:243], v[48:51], 0
    s_nop 4
    v_pk_mul_f32 v[232:233], v[208:209], v[52:53]
    v_pk_mul_f32 v[236:237], v[212:213], v[52:53]
    v_pk_fma_f32 v[232:233], v[212:213], v[60:61], v[232:233]
    v_pk_fma_f32 v[236:237], v[208:209], v[60:61], v[236:237] neg_lo:[1,0,0] neg_hi:[1,0,0]
    v_pk_mul_f32 v[234:235], v[210:211], v[54:55]
    v_pk_mul_f32 v[238:239], v[214:215], v[54:55]
    v_pk_fma_f32 v[234:235], v[214:215], v[62:63], v[234:235]
    v_pk_fma_f32 v[238:239], v[210:211], v[62:63], v[238:239] neg_lo:[1,0,0] neg_hi:[1,0,0]
    v_cvt_pk_f16_f32 v224, v232, v233
    v_cvt_pk_f16_f32 v225, v234, v235
    v_cvt_pk_f16_f32 v226, v236, v237
    v_cvt_pk_f16_f32 v227, v238, v239
    s_nop 1
    v_mfma_f32_16x16x32_f16 v[244:247], v[68:71], v[224:227], 0
    v_pk_mul_f32 v[232:233], v[216:217], v[56:57]
    v_pk_mul_f32 v[236:237], v[220:221], v[56:57]
    v_pk_fma_f32 v[232:233], v[220:221], v[64:65], v[232:233]
    v_pk_fma_f32 v[236:237], v[216:217], v[64:65], v[236:237] neg_lo:[1,0,0] neg_hi:[1,0,0]
    v_pk_mul_f32 v[234:235], v[218:219], v[58:59]
    v_pk_mul_f32 v[238:239], v[222:223], v[58:59]
    v_pk_fma_f32 v[234:235], v[222:223], v[66:67], v[234:235]
    v_pk_fma_f32 v[238:239], v[218:219], v[66:67], v[238:239] neg_lo:[1,0,0] neg_hi:[1,0,0]
    v_cvt_pk_f16_f32 v228, v232, v233
    v_cvt_pk_f16_f32 v229, v234, v235
    v_cvt_pk_f16_f32 v230, v236, v237
    v_cvt_pk_f16_f32 v231, v238, v239
    s_nop 1
    v_mfma_f32_16x16x32_f16 v[248:251], v[68:71], v[228:231], 0
    v_mul_f32 v244, 0x3d800000, v244
    v_mul_f32 v245, 0x3d800000, v245
    v_mul_f32 v246, 0x3d800000, v246
    v_mul_f32 v247, 0x3d800000, v247
    s_nop 3
    v_mul_f32 v248, 0x3d800000, v248
    v_mul_f32 v249, 0x3d800000, v249
    v_mul_f32 v250, 0x3d800000, v250
    v_mul_f32 v251, 0x3d800000, v251
    v_cvt_pk_f16_f32 v252, v244, v245
    v_cvt_pk_f16_f32 v253, v246, v247
    v_cvt_pk_f16_f32 v254, v248, v249
    v_cvt_pk_f16_f32 v255, v250, v251
    v_lshl_add_u32 v208, v3, 7, v2
    v_lshlrev_b32 v208, 1, v208
    v_sub_u32 v209, 800, v208
    v_mov_b32 v210, 512
    s_mov_b32 exec_lo, -1
    s_mov_b32 exec_hi, 0
    ds_write_b16 v208, v252 offset:26048
    ds_write_b16 v209, v252 offset:26272
    ds_write_b16_d16_hi v208, v252 offset:26112
    ds_write_b16_d16_hi v209, v252 offset:26208
    ds_write_b16 v208, v253 offset:26176
    ds_write_b16 v209, v253 offset:26144
    ds_write_b16_d16_hi v208, v253 offset:26240
    ds_write_b16_d16_hi v209, v253 offset:26080
    ds_write_b16 v208, v254 offset:26080
    ds_write_b16 v209, v254 offset:26240
    ds_write_b16_d16_hi v208, v254 offset:26144
    ds_write_b16_d16_hi v209, v254 offset:26176
    ds_write_b16 v208, v255 offset:26208
    ds_write_b16 v209, v255 offset:26112
    ds_write_b16_d16_hi v208, v255 offset:26272
    ds_write_b16_d16_hi v209, v255 offset:26048
    s_mov_b32 exec_lo, 0
    s_mov_b32 exec_hi, 0x00010000
    ds_write_b16_d16_hi v210, v253 offset:26048
    s_mov_b64 exec, -1
    v_lshlrev_b32 v211, 4, v1
    s_waitcnt lgkmcnt(0)
    ds_read_b128 v[212:215], v211 offset:26048
    s_mov_b32 s25, 9441280
    s_waitcnt lgkmcnt(0)
    buffer_store_dwordx4 v[212:215], v211, s[4:7], s25 offen sc1
L_nok_2:
    s_mov_b32 s16, s84
    s_mov_b32 s17, s85
    s_mov_b32 s18, 1024
    s_mov_b32 s19, 0x00020000
    v_lshlrev_b32 v210, 4, v1
    v_sub_u32 v211, 1008, v210
    buffer_load_dwordx4 v[192:195], v210, s[16:19], 0 offen
    buffer_load_dwordx4 v[196:199], v211, s[16:19], 0 offen
    v_add_u32 v212, 0, v183
    global_load_dwordx4 v[168:171], v212, s[64:65]
    v_add_u32 v212, 4096, v183
    global_load_dwordx4 v[172:175], v212, s[64:65]
    s_lshl_b32 s27, s20, 4
    v_lshlrev_b32 v180, 12, v0
    v_add_u32 v179, s27, v180
    v_mov_b32 v228, s22
    v_mov_b32 v229, s23
    v_cmp_gt_u32 vcc, 32, v1
    s_lshl_b32 s27, s68, 11
    s_cmp_lt_u32 s68, 172
    s_cselect_b32 s27, s27, 0x7f000000
    v_cndmask_b32 v184, v229, v228, vcc
    v_lshlrev_b32 v181, 3, v0
    v_add_u32 v181, s27, v181
    v_mov_b32 v228, 0
    v_lshlrev_b32 v229, 10, v1
    s_mov_b64 exec, 31
    ds_write_b16 v229, v228 offset:0
    s_mov_b64 exec, -1
    s_sub_u32 s29, s20, 192
    s_bitcmp1_b32 s20, 0
    s_cselect_b32 s29, -1, s29
    s_lshr_b32 s29, s29, 1
    s_lshl_b32 s27, s29, 6
    v_lshlrev_b32 v218, 2, v0
    v_add_u32 v218, s27, v218
    v_cmp_gt_u32 vcc, 16, v0
    s_cmp_lt_u32 s29, 32
    s_cselect_b64 s[40:41], vcc, 0
    v_mov_b32 v219, 0x7f000000
    v_cndmask_b32 v218, v219, v218, s[40:41]
    v_mov_b32 v248, -1
    v_mov_b32 v249, -1
    v_mov_b32 v250, -1
    v_mov_b32 v251, -1
    s_mov_b32 s25, 8388608
    buffer_store_dwordx2 v[248:249], v181, s[4:7], s25 offen sc1
    s_mov_b32 s25, 9437184
    buffer_store_dword v248, v218, s[4:7], s25 offen sc1
    s_bfe_u32 s27, s20, 0x10003
    s_lshl_b32 s27, s27, 4
    v_xor_b32 v247, s27, v183
    v_add_u32 v247, 8192, v247
    global_load_dwordx4 v[252:255], v247, s[64:65]
    v_and_b32 v187, 7, v1
    v_lshlrev_b32 v187, 8, v187
    s_cmp_lg_u32 s21, 0
    s_cbranch_scc1 L_hw_3
    s_mov_b32 s25, 9449472
    buffer_load_dword v188, v187, s[4:7], s25 offen  sc1
L_hw_3:
    s_lshl_b32 s27, s21, 3
    v_and_b32 v236, 7, v2
    v_add_u32 v236, s27, v236
    v_sub_u32 v228, 64, v236
    v_mov_b32 v229, 32
    v_cmp_eq_u32 s[42:43], 0, v236
    s_nop 1
    v_cndmask_b32 v228, v228, v229, s[42:43]
    v_cmp_le_u32 vcc, 8, v2
    s_nop 1
    v_cndmask_b32 v237, v236, v228, vcc
    s_andn2_b64 s[44:45], vcc, s[42:43]
    v_cvt_f32_u32 v240, v3
    v_cmp_le_u32 vcc, 8, v2
    s_nop 0
    s_and_b64 vcc, vcc, s[42:43]
    v_mov_b32 v229, 32
    v_cndmask_b32 v228, v236, v229, vcc
    v_cvt_f32_u32 v242, v228
    v_mul_f32 v242, 0x3c800000, v242
    v_mov_b32 v244, 0x3e800000
    v_cndmask_b32 v244, 0, v244, s[44:45]
    v_mul_f32 v243, 0x41000000, v240
    v_fma_f32 v243, v243, v242, v244
    v_cos_f32 v238, v243
    v_add_f32 v243, v243, v242
    v_cos_f32 v239, v243
    v_add_f32 v243, v243, v242
    v_cvt_pk_f16_f32 v72, v238, v239
    v_cos_f32 v238, v243
    v_add_f32 v243, v243, v242
    v_cos_f32 v239, v243
    v_add_f32 v243, v243, v242
    v_cvt_pk_f16_f32 v73, v238, v239
    v_cos_f32 v238, v243
    v_add_f32 v243, v243, v242
    v_cos_f32 v239, v243
    v_add_f32 v243, v243, v242
    v_cvt_pk_f16_f32 v74, v238, v239
    v_cos_f32 v238, v243
    v_add_f32 v243, v243, v242
    v_cos_f32 v239, v243
    s_nop 0
    v_cvt_pk_f16_f32 v75, v238, v239
    v_and_b32 v228, 1, v228
    v_mul_u32_u24 v228, 0x8000, v228
    v_lshl_or_b32 v228, v228, 16, v228
    v_xor_b32 v76, v228, v72
    v_xor_b32 v77, v228, v73
    v_xor_b32 v78, v228, v74
    v_xor_b32 v79, v228, v75
    s_cmp_lg_u32 s21, 0
    s_cbranch_scc1 L_hw2_4
    s_mov_b32 s26, 0
    s_mov_b32 s25, 9449472
L_hp_5:
    s_waitcnt vmcnt(0)
    v_cmp_ne_u32 vcc, s53, v188
    s_cbranch_vccz L_hw2_4
    s_add_u32 s26, s26, 1
    s_cmp_gt_u32 s26, 40000
    s_cbranch_scc1 L_hw2_4
    s_sleep 4
    buffer_load_dword v188, v187, s[4:7], s25 offen  sc1
    s_branch L_hp_5
L_hw2_4:
    s_waitcnt vmcnt(0)
    s_barrier
    s_mov_b32 s25, 1048576
    v_lshrrev_b32 v216, 1, v0
    v_lshlrev_b32 v216, 13, v216
    v_and_b32 v217, 1, v0
    v_lshl_add_u32 v216, v217, 4, v216
    s_lshl_b32 s27, s20, 5
    v_add_u32 v216, s27, v216
    s_add_u32 s29, s25, 1048576
    buffer_load_dwordx4 v[208:211], v216, s[4:7], s25 offen  sc1
    buffer_load_dwordx4 v[212:215], v216, s[4:7], s29 offen  sc1
    v_cvt_f32_u32 v240, v3
    v_cvt_f32_u32 v242, v237
    v_mul_f32 v242, 0x3a000000, v242
    v_mul_f32 v243, v240, v242
    v_fma_f32 v243, v243, 4.0, v244
    v_mov_b32 v229, 0x3e800000
    v_cndmask_b32 v229, v229, 0, s[42:43]
    v_add_f32 v245, 0xbe800000, v243
    v_mul_f32 v230, 0x41400000, v242
    v_cos_f32 v238, v243
    v_cos_f32 v239, v245
    v_add_f32 v243, v243, v242
    v_add_f32 v245, v245, v242
    v_mul_f32 v80, 0x3e800000, v238
    v_mul_f32 v84, v229, v239
    v_mul_f32 v88, 0xbe800000, v239
    v_mul_f32 v92, v229, v238
    v_cos_f32 v238, v243
    v_cos_f32 v239, v245
    v_add_f32 v243, v243, v242
    v_add_f32 v245, v245, v242
    v_mul_f32 v81, 0x3e800000, v238
    v_mul_f32 v85, v229, v239
    v_mul_f32 v89, 0xbe800000, v239
    v_mul_f32 v93, v229, v238
    v_cos_f32 v238, v243
    v_cos_f32 v239, v245
    v_add_f32 v243, v243, v242
    v_add_f32 v245, v245, v242
    v_mul_f32 v82, 0x3e800000, v238
    v_mul_f32 v86, v229, v239
    v_mul_f32 v90, 0xbe800000, v239
    v_mul_f32 v94, v229, v238
    v_cos_f32 v238, v243
    v_cos_f32 v239, v245
    v_add_f32 v243, v243, v242
    v_add_f32 v245, v245, v242
    v_mul_f32 v83, 0x3e800000, v238
    v_mul_f32 v87, v229, v239
    v_mul_f32 v91, 0xbe800000, v239
    v_mul_f32 v95, v229, v238
    v_add_f32 v243, v243, v230
    v_add_f32 v245, v245, v230
    v_cos_f32 v238, v243
    v_cos_f32 v239, v245
    v_add_f32 v243, v243, v242
    v_add_f32 v245, v245, v242
    v_mul_f32 v96, 0x3e800000, v238
    v_mul_f32 v100, v229, v239
    v_mul_f32 v104, 0xbe800000, v239
    v_mul_f32 v108, v229, v238
    v_cos_f32 v238, v243
    v_cos_f32 v239, v245
    v_add_f32 v243, v243, v242
    v_add_f32 v245, v245, v242
    v_mul_f32 v97, 0x3e800000, v238
    v_mul_f32 v101, v229, v239
    v_mul_f32 v105, 0xbe800000, v239
    v_mul_f32 v109, v229, v238
    v_cos_f32 v238, v243
    v_cos_f32 v239, v245
    v_add_f32 v243, v243, v242
    v_add_f32 v245, v245, v242
    v_mul_f32 v98, 0x3e800000, v238
    v_mul_f32 v102, v229, v239
    v_mul_f32 v106, 0xbe800000, v239
    v_mul_f32 v110, v229, v238
    v_cos_f32 v238, v243
    v_cos_f32 v239, v245
    v_add_f32 v243, v243, v242
    v_add_f32 v245, v245, v242
    v_mul_f32 v99, 0x3e800000, v238
    v_mul_f32 v103, v229, v239
    v_mul_f32 v107, 0xbe800000, v239
    v_mul_f32 v111, v229, v238
    v_cvt_f32_u32 v242, v2
    v_mul_f32 v242, 0x3d000000, v242
    v_mul_f32 v245, v240, v242
    v_mul_f32 v245, 4.0, v245
    v_add_f32 v243, 0xbe000000, v245
    v_cos_f32 v238, v243
    v_add_f32 v243, v243, v242
    v_cos_f32 v239, v243
    v_add_f32 v243, v243, v242
    v_mul_f32 v238, 0x3e3504f3, v238
    v_mul_f32 v239, 0x3e3504f3, v239
    v_cvt_pk_f16_f32 v112, v238, v239
    v_cos_f32 v238, v243
    v_add_f32 v243, v243, v242
    v_cos_f32 v239, v243
    v_mul_f32 v238, 0x3e3504f3, v238
    v_mul_f32 v239, 0x3e3504f3, v239
    v_cvt_pk_f16_f32 v113, v238, v239
    v_add_f32 v243, 0xbec00000, v245
    v_cos_f32 v238, v243
    v_add_f32 v243, v243, v242
    v_cos_f32 v239, v243
    v_add_f32 v243, v243, v242
    v_mul_f32 v238, 0x3e3504f3, v238
    v_mul_f32 v239, 0x3e3504f3, v239
    v_cvt_pk_f16_f32 v114, v238, v239
    v_cos_f32 v238, v243
    v_add_f32 v243, v243, v242
    v_cos_f32 v239, v243
    v_mul_f32 v238, 0x3e3504f3, v238
    v_mul_f32 v239, 0x3e3504f3, v239
    v_cvt_pk_f16_f32 v115, v238, v239
    v_and_b32 v228, 1, v2
    v_mul_u32_u24 v228, 0x8000, v228
    v_lshl_or_b32 v228, v228, 16, v228
    v_xor_b32 v116, v228, v112
    v_xor_b32 v117, v228, v113
    v_xor_b32 v118, v228, v114
    v_xor_b32 v119, v228, v115
    v_xor_b32 v120, 0x80000000, v112
    v_xor_b32 v121, 0x80000000, v113
    v_xor_b32 v122, 0x80000000, v114
    v_xor_b32 v123, 0x80000000, v115
    v_xor_b32 v124, 0x80000000, v116
    v_xor_b32 v125, 0x80000000, v117
    v_xor_b32 v126, 0x80000000, v118
    v_xor_b32 v127, 0x80000000, v119
    s_waitcnt vmcnt(0)
    v_bitop3_b32 v186, v209, v211, s53 bitop3:0x7e
    v_bitop3_b32 v209, v213, v215, s53 bitop3:0x7e
    v_or_b32 v186, v186, v209
    v_cmp_ne_u32 vcc, 0, v186
    s_cbranch_vccnz L_poll_6
L_ok_7:
    ds_write_b16 v252, v208
    ds_write_b16_d16_hi v253, v208 offset:16
    ds_write_b16 v253, v210 offset:32
    ds_write_b16_d16_hi v253, v210 offset:48
    ds_write_b16 v254, v212
    ds_write_b16_d16_hi v255, v212 offset:16
    ds_write_b16 v255, v214 offset:32
    ds_write_b16_d16_hi v255, v214 offset:48
    s_waitcnt lgkmcnt(0)
    s_barrier
    ds_read_b128 v[208:211], v163 offset:0
    ds_read_b128 v[212:215], v163 offset:1088
    ds_read_b128 v[216:219], v163 offset:2208
    ds_read_b128 v[220:223], v163 offset:3296
    s_waitcnt lgkmcnt(3)
    v_mfma_f32_16x16x32_f16 v[224:227], v[208:211], v[72:75], 0
    s_waitcnt lgkmcnt(2)
    v_mfma_f32_16x16x32_f16 v[224:227], v[212:215], v[76:79], v[224:227]
    s_waitcnt lgkmcnt(1)
    v_mfma_f32_16x16x32_f16 v[228:231], v[216:219], v[72:75], 0
    s_waitcnt lgkmcnt(0)
    v_mfma_f32_16x16x32_f16 v[228:231], v[220:223], v[76:79], v[228:231]
    s_nop 3
    v_mov_b32_dpp v232, v224 row_ror:8 row_mask:0xf bank_mask:0xf
    v_mov_b32_dpp v233, v225 row_ror:8 row_mask:0xf bank_mask:0xf
    v_mov_b32_dpp v234, v226 row_ror:8 row_mask:0xf bank_mask:0xf
    v_mov_b32_dpp v235, v227 row_ror:8 row_mask:0xf bank_mask:0xf
    v_pk_mul_f32 v[236:237], v[224:225], v[80:81]
    v_pk_mul_f32 v[240:241], v[224:225], v[88:89]
    v_pk_mul_f32 v[238:239], v[226:227], v[82:83]
    v_pk_mul_f32 v[242:243], v[226:227], v[90:91]
    v_pk_fma_f32 v[236:237], v[232:233], v[84:85], v[236:237]
    v_pk_fma_f32 v[240:241], v[232:233], v[92:93], v[240:241]
    v_pk_fma_f32 v[238:239], v[234:235], v[86:87], v[238:239]
    v_pk_fma_f32 v[242:243], v[234:235], v[94:95], v[242:243]
    v_cvt_pk_f16_f32 v208, v236, v237
    v_cvt_pk_f16_f32 v209, v238, v239
    v_cvt_pk_f16_f32 v210, v240, v241
    v_cvt_pk_f16_f32 v211, v242, v243
    s_nop 1
    v_mfma_f32_16x16x32_f16 v[216:219], v[112:115], v[208:211], 0
    v_mfma_f32_16x16x32_f16 v[220:223], v[120:123], v[208:211], 0
    v_mov_b32_dpp v232, v228 row_ror:8 row_mask:0xf bank_mask:0xf
    v_mov_b32_dpp v233, v229 row_ror:8 row_mask:0xf bank_mask:0xf
    v_mov_b32_dpp v234, v230 row_ror:8 row_mask:0xf bank_mask:0xf
    v_mov_b32_dpp v235, v231 row_ror:8 row_mask:0xf bank_mask:0xf
    v_pk_mul_f32 v[236:237], v[228:229], v[96:97]
    v_pk_mul_f32 v[240:241], v[228:229], v[104:105]
    v_pk_mul_f32 v[238:239], v[230:231], v[98:99]
    v_pk_mul_f32 v[242:243], v[230:231], v[106:107]
    v_pk_fma_f32 v[236:237], v[232:233], v[100:101], v[236:237]
    v_pk_fma_f32 v[240:241], v[232:233], v[108:109], v[240:241]
    v_pk_fma_f32 v[238:239], v[234:235], v[102:103], v[238:239]
    v_pk_fma_f32 v[242:243], v[234:235], v[110:111], v[242:243]
    v_cvt_pk_f16_f32 v212, v236, v237
    v_cvt_pk_f16_f32 v213, v238, v239
    v_cvt_pk_f16_f32 v214, v240, v241
    v_cvt_pk_f16_f32 v215, v242, v243
    s_nop 1
    v_mfma_f32_16x16x32_f16 v[216:219], v[116:119], v[212:215], v[216:219]
    v_mfma_f32_16x16x32_f16 v[220:223], v[124:127], v[212:215], v[220:223]
    s_nop 6
    v_cvt_pk_f16_f32 v224, v216, v217
    v_cvt_pk_f16_f32 v225, v218, v219
    ds_write_b16 v172, v224
    ds_write_b16_d16_hi v172, v224 offset:256
    v_cvt_pk_f16_f32 v226, v220, v221
    v_cvt_pk_f16_f32 v227, v222, v223
    ds_write_b16 v172, v225 offset:512
    ds_write_b16_d16_hi v172, v225 offset:768
    ds_write_b16 v174, v226
    ds_write_b16_d16_hi v173, v226 offset:512
    ds_write_b16 v173, v227 offset:256
    ds_write_b16_d16_hi v173, v227
    s_waitcnt lgkmcnt(0)
    s_barrier
    ds_read_b128 v[208:211], v183 offset:21952
    s_mov_b32 s25, 3145728
    s_waitcnt lgkmcnt(0)
    buffer_store_dwordx4 v[208:211], v178, s[4:7], s25 offen sc1
    v_mov_b32 v248, -1
    v_mov_b32 v249, -1
    v_mov_b32 v250, -1
    v_mov_b32 v251, -1
    s_mov_b32 s25, 5242880
    buffer_store_dwordx4 v[248:251], v178, s[4:7], s25 offen sc1
    s_mov_b32 s25, 7340032
    buffer_store_dwordx4 v[248:251], v178, s[4:7], s25 offen sc1
    s_mov_b32 s25, 8912896
    buffer_store_dwordx2 v[248:249], v181, s[4:7], s25 offen sc1
    s_cmp_lg_u32 s22, 0
    s_cbranch_scc1 L_nononce_8
    v_mov_b32 v208, s53
    v_mov_b32 v209, 0
    s_mov_b64 exec, 1
    s_mov_b32 s25, 0
    buffer_store_dword v208, v209, s[4:7], s25 offen sc1
    s_mov_b64 exec, -1
L_nononce_8:
    s_cmp_eq_u32 s20, 0
    s_cselect_b32 s27, 4096, 0
    v_add_u32 v182, s27, v175
    v_lshlrev_b32 v20, 16, v192
    v_and_b32 v21, 0xffff0000, v192
    v_lshlrev_b32 v22, 16, v193
    v_and_b32 v23, 0xffff0000, v193
    v_lshlrev_b32 v24, 16, v194
    v_and_b32 v25, 0xffff0000, v194
    v_lshlrev_b32 v26, 16, v195
    v_and_b32 v27, 0xffff0000, v195
    v_lshlrev_b32 v224, 16, v196
    v_and_b32 v35, 0xffff0000, v196
    v_lshlrev_b32 v34, 16, v197
    v_and_b32 v33, 0xffff0000, v197
    v_mov_b32_dpp v28, v224 wave_ror:1 row_mask:0xf bank_mask:0xf
    v_lshlrev_b32 v32, 16, v198
    v_and_b32 v31, 0xffff0000, v198
    v_lshlrev_b32 v30, 16, v199
    v_and_b32 v29, 0xffff0000, v199
    v_pk_add_f32 v[224:225], v[20:21], v[22:23]
    v_pk_add_f32 v[226:227], v[24:25], v[26:27]
    v_pk_add_f32 v[224:225], v[224:225], v[226:227]
    v_add_f32 v224, v224, v225
    s_nop 1
    v_add_f32_dpp v224, v224, v224 row_ror:8 row_mask:0xf bank_mask:0xf
    s_nop 1
    v_add_f32_dpp v224, v224, v224 row_ror:4 row_mask:0xf bank_mask:0xf
    s_nop 1
    v_add_f32_dpp v224, v224, v224 row_ror:2 row_mask:0xf bank_mask:0xf
    s_nop 1
    v_add_f32_dpp v224, v224, v224 row_ror:1 row_mask:0xf bank_mask:0xf
    v_mov_b32 v225, v224
    s_nop 1
    v_permlane16_swap_b32 v224, v225
    v_add_f32 v224, v224, v225
    v_mov_b32 v225, v224
    s_nop 1
    v_permlane32_swap_b32 v224, v225
    v_add_f32 v224, v224, v225
    s_nop 0
    v_readfirstlane_b32 s34, v224
    s_waitcnt vmcnt(0)
    s_bitcmp0_b32 s21, 0
    s_cbranch_scc1 L_nok_9
    v_lshlrev_b32 v224, 4, v1
    s_mov_b32 s29, 9441280
    buffer_load_dwordx4 v[220:223], v224, s[4:7], s29 offen  sc1
L_nok_9:
    s_mov_b32 s25, 3145728
    buffer_load_dwordx4 v[208:211], v179, s[4:7], s25 offen  sc1
    s_waitcnt vmcnt(0)
    v_max3_u32 v186, v208, v209, v210
    v_max_u32 v186, v186, v211
    v_cmp_eq_u32 vcc, -1, v186
    s_cbranch_vccnz L_poll_10
L_ok_11:
    ds_write_b16 v171, v208 offset:0
    ds_write_b16_d16_hi v171, v208 offset:1024
    ds_write_b16 v171, v209 offset:2048
    ds_write_b16_d16_hi v171, v209 offset:3072
    ds_write_b16 v182, v210 offset:0
    ds_write_b16_d16_hi v175, v210 offset:3072
    ds_write_b16 v175, v211 offset:2048
    ds_write_b16_d16_hi v175, v211 offset:1024
    s_cmp_lg_u32 s20, 0
    s_cbranch_scc1 L_not0_12
    ds_write_b16 v175, v208 offset:0
    ds_write_b16 v171, v210 offset:4096
L_not0_12:
    s_waitcnt lgkmcnt(0)
    s_barrier
    ds_read_b128 v[212:215], v160 offset:0
    s_cmp_lg_u32 s22, 0
    s_cbranch_scc1 L_yv_13
    ds_read_b128 v[216:219], v160 offset:4096
L_yv_13:
    s_bitcmp0_b32 s21, 0
    s_cbranch_scc1 L_nok2_14
    v_max3_u32 v186, v220, v221, v222
    v_max_u32 v186, v186, v223
    v_cmp_eq_u32 vcc, -1, v186
    s_cbranch_vccnz L_poll_15
L_ok_16:
    s_waitcnt lgkmcnt(0)
    v_pk_add_f16 v212, v212, v220
    v_pk_add_f16 v213, v213, v221
    v_pk_add_f16 v214, v214, v222
    v_pk_add_f16 v215, v215, v223
L_nok2_14:
    s_waitcnt lgkmcnt(0)
    s_cmp_eq_u32 s22, 0
    s_cbranch_scc1 L_ysp_17
    v_fma_mix_f32 v4, v212, s30, v4 op_sel:[0,0,0] op_sel_hi:[1,0,0]
    v_fma_mix_f32 v5, v212, s30, v5 op_sel:[1,0,0] op_sel_hi:[1,0,0]
    v_fma_mix_f32 v6, v213, s30, v6 op_sel:[0,0,0] op_sel_hi:[1,0,0]
    v_fma_mix_f32 v7, v213, s30, v7 op_sel:[1,0,0] op_sel_hi:[1,0,0]
    v_fma_mix_f32 v8, v214, s30, v8 op_sel:[0,0,0] op_sel_hi:[1,0,0]
    v_fma_mix_f32 v9, v214, s30, v9 op_sel:[1,0,0] op_sel_hi:[1,0,0]
    v_fma_mix_f32 v10, v215, s30, v10 op_sel:[0,0,0] op_sel_hi:[1,0,0]
    v_fma_mix_f32 v11, v215, s30, v11 op_sel:[1,0,0] op_sel_hi:[1,0,0]
    v_fma_mix_f32 v12, v212, s30, v12 op_sel:[0,0,0] op_sel_hi:[1,0,0]
    v_fma_mix_f32 v13, v212, s30, v13 op_sel:[1,0,0] op_sel_hi:[1,0,0]
    v_fma_mix_f32 v14, v213, s30, v14 op_sel:[0,0,0] op_sel_hi:[1,0,0]
    v_fma_mix_f32 v15, v213, s30, v15 op_sel:[1,0,0] op_sel_hi:[1,0,0]
    v_fma_mix_f32 v16, v214, s30, v16 op_sel:[0,0,0] op_sel_hi:[1,0,0]
    v_fma_mix_f32 v17, v214, s30, v17 op_sel:[1,0,0] op_sel_hi:[1,0,0]
    v_fma_mix_f32 v18, v215, s30, v18 op_sel:[0,0,0] op_sel_hi:[1,0,0]
    v_fma_mix_f32 v19, v215, s30, v19 op_sel:[1,0,0] op_sel_hi:[1,0,0]
L_yj_18:
    v_readfirstlane_b32 s36, v4
    v_readfirstlane_b32 s38, v12
    s_nop 0
    v_pk_add_f32 v[208:209], v[4:5], s[36:37] op_sel_hi:[1,0] neg_lo:[0,1] neg_hi:[0,1]
    v_pk_add_f32 v[210:211], v[6:7], s[36:37] op_sel_hi:[1,0] neg_lo:[0,1] neg_hi:[0,1]
    v_pk_add_f32 v[212:213], v[8:9], s[36:37] op_sel_hi:[1,0] neg_lo:[0,1] neg_hi:[0,1]
    v_pk_add_f32 v[214:215], v[10:11], s[36:37] op_sel_hi:[1,0] neg_lo:[0,1] neg_hi:[0,1]
    v_pk_add_f32 v[232:233], v[208:209], v[210:211]
    v_pk_mul_f32 v[234:235], v[208:209], v[208:209]
    v_pk_add_f32 v[236:237], v[212:213], v[214:215]
    v_pk_mul_f32 v[238:239], v[208:209], v[20:21]
    v_pk_fma_f32 v[234:235], v[210:211], v[210:211], v[234:235]
    v_pk_fma_f32 v[238:239], v[210:211], v[22:23], v[238:239]
    v_pk_add_f32 v[232:233], v[232:233], v[236:237]
    v_pk_fma_f32 v[234:235], v[212:213], v[212:213], v[234:235]
    v_pk_fma_f32 v[238:239], v[212:213], v[24:25], v[238:239]
    v_pk_fma_f32 v[234:235], v[214:215], v[214:215], v[234:235]
    v_pk_fma_f32 v[238:239], v[214:215], v[26:27], v[238:239]
    v_add_f32 v224, v232, v233
    v_add_f32 v225, v234, v235
    v_add_f32 v226, v238, v239
    v_pk_add_f32 v[216:217], v[12:13], s[38:39] op_sel_hi:[1,0] neg_lo:[0,1] neg_hi:[0,1]
    v_pk_add_f32 v[218:219], v[14:15], s[38:39] op_sel_hi:[1,0] neg_lo:[0,1] neg_hi:[0,1]
    v_pk_add_f32 v[220:221], v[16:17], s[38:39] op_sel_hi:[1,0] neg_lo:[0,1] neg_hi:[0,1]
    v_pk_add_f32 v[222:223], v[18:19], s[38:39] op_sel_hi:[1,0] neg_lo:[0,1] neg_hi:[0,1]
    v_pk_add_f32 v[240:241], v[216:217], v[218:219]
    v_pk_mul_f32 v[242:243], v[216:217], v[216:217]
    v_pk_add_f32 v[244:245], v[220:221], v[222:223]
    v_pk_mul_f32 v[246:247], v[216:217], v[28:29]
    v_pk_fma_f32 v[242:243], v[218:219], v[218:219], v[242:243]
    v_pk_fma_f32 v[246:247], v[218:219], v[30:31], v[246:247]
    v_pk_add_f32 v[240:241], v[240:241], v[244:245]
    v_pk_fma_f32 v[242:243], v[220:221], v[220:221], v[242:243]
    v_pk_fma_f32 v[246:247], v[220:221], v[32:33], v[246:247]
    v_pk_fma_f32 v[242:243], v[222:223], v[222:223], v[242:243]
    v_pk_fma_f32 v[246:247], v[222:223], v[34:35], v[246:247]
    v_add_f32 v227, v240, v241
    v_add_f32 v228, v242, v243
    v_add_f32 v229, v246, v247
    v_permlane32_swap_b32 v224, v227
    v_permlane32_swap_b32 v225, v228
    v_permlane32_swap_b32 v226, v229
    v_add_f32 v224, v224, v227
    v_add_f32 v225, v225, v228
    v_add_f32 v226, v226, v229
    v_add_f32_dpp v224, v224, v224 row_ror:8 row_mask:0xf bank_mask:0xf
    v_add_f32_dpp v225, v225, v225 row_ror:8 row_mask:0xf bank_mask:0xf
    v_add_f32_dpp v226, v226, v226 row_ror:8 row_mask:0xf bank_mask:0xf
    v_add_f32_dpp v224, v224, v224 row_ror:4 row_mask:0xf bank_mask:0xf
    v_add_f32_dpp v225, v225, v225 row_ror:4 row_mask:0xf bank_mask:0xf
    v_add_f32_dpp v226, v226, v226 row_ror:4 row_mask:0xf bank_mask:0xf
    v_add_f32_dpp v224, v224, v224 row_ror:2 row_mask:0xf bank_mask:0xf
    v_add_f32_dpp v225, v225, v225 row_ror:2 row_mask:0xf bank_mask:0xf
    v_add_f32_dpp v226, v226, v226 row_ror:2 row_mask:0xf bank_mask:0xf
    v_add_f32_dpp v224, v224, v224 row_ror:1 row_mask:0xf bank_mask:0xf
    v_add_f32_dpp v225, v225, v225 row_ror:1 row_mask:0xf bank_mask:0xf
    v_add_f32_dpp v226, v226, v226 row_ror:1 row_mask:0xf bank_mask:0xf
    v_mov_b32 v227, v224
    v_mov_b32 v228, v225
    v_mov_b32 v229, v226
    v_permlane16_swap_b32 v224, v227
    v_permlane16_swap_b32 v225, v228
    v_permlane16_swap_b32 v226, v229
    v_add_f32 v224, v224, v227
    v_add_f32 v225, v225, v228
    v_add_f32 v226, v226, v229
    v_mul_f32 v248, 0x3b000000, v224
    v_mul_f32 v225, 0x3b000000, v225
    v_fma_f32 v249, -v248, v248, v225
    v_add_f32 v225, 0x3727c5ac, v249
    v_rsq_f32 v250, v225
    v_fma_f32 v226, -v248, s34, v226
    v_mul_f32 v251, -v248, v250
    v_mul_f32 v252, v250, v226
    v_ashrrev_i32 v230, 31, v252
    v_or_b32 v230, 0x80000000, v230
    v_xor_b32 v230, v252, v230
    v_and_b32 v230, 0xfffff800, v230
    v_or_b32 v230, v184, v230
    s_nop 0
    v_readlane_b32 s50, v230, 0
    v_readlane_b32 s51, v230, 32
    s_lshl_b32 s27, s21, 2
    v_mov_b32 v231, s27
    s_max_u32 s52, s50, s51
    v_mov_b32 v230, s52
    ds_write_b32 v231, v230 offset:27392
    v_mov_b32 v230, s36
    v_mov_b32 v231, s38
    v_cmp_gt_u32 vcc, 32, v1
    v_add_f32 v229, 1.0, v250
    s_nop 0
    v_cndmask_b32 v230, v231, v230, vcc
    v_add_f32 v230, v230, v251
    v_readlane_b32 s42, v229, 0
    v_readlane_b32 s44, v229, 32
    v_readlane_b32 s43, v230, 0
    v_readlane_b32 s45, v230, 32
    v_mul_f32 v231, v229, v229
    v_mul_f32 v231, v231, v249
    v_add_f32 v231, 0x3727c5ac, v231
    v_rsq_f32 v231, v231
    s_waitcnt lgkmcnt(0)
    s_barrier
    v_mov_b32 v236, 0
    ds_read_b128 v[232:235], v236 offset:27392
    v_mul_f32 v230, v229, v231
    v_mul_f32 v231, -v248, v230
    v_readlane_b32 s46, v230, 0
    v_readlane_b32 s47, v231, 0
    v_readlane_b32 s48, v230, 32
    v_readlane_b32 s49, v231, 32
    s_waitcnt lgkmcnt(0)
    v_max3_u32 v232, v232, v233, v234
    v_max_u32 v232, v232, v235
    s_nop 0
    v_readfirstlane_b32 s27, v232
    s_nop 0
    s_cmp_eq_u32 s27, s52
    s_cselect_b32 s69, 1, 0
    s_cbranch_scc0 L_nohdr_19
    s_lshl_b32 s27, s20, 12
    s_add_u32 s25, s27, 6291456
    v_mov_b32 v233, s52
    s_mov_b64 exec, 1
    buffer_store_dword v233, v236, s[4:7], s25 offen sc1
    s_mov_b64 exec, -1
L_nohdr_19:
    v_pk_fma_f32 v[224:225], v[208:209], s[46:47], s[46:47] op_sel:[0,0,1] op_sel_hi:[1,0,1]
    v_pk_fma_f32 v[226:227], v[210:211], s[46:47], s[46:47] op_sel:[0,0,1] op_sel_hi:[1,0,1]
    v_pk_fma_f32 v[228:229], v[212:213], s[46:47], s[46:47] op_sel:[0,0,1] op_sel_hi:[1,0,1]
    v_pk_fma_f32 v[230:231], v[214:215], s[46:47], s[46:47] op_sel:[0,0,1] op_sel_hi:[1,0,1]
    v_pk_fma_f32 v[224:225], v[216:217], s[48:49], v[224:225] op_sel_hi:[1,0,1]
    v_pk_fma_f32 v[226:227], v[218:219], s[48:49], v[226:227] op_sel_hi:[1,0,1]
    v_pk_fma_f32 v[228:229], v[220:221], s[48:49], v[228:229] op_sel_hi:[1,0,1]
    v_pk_fma_f32 v[230:231], v[222:223], s[48:49], v[230:231] op_sel_hi:[1,0,1]
    v_cvt_pk_f16_f32 v232, v224, v225
    v_cvt_pk_f16_f32 v233, v226, v227
    v_cvt_pk_f16_f32 v234, v228, v229
    v_cvt_pk_f16_f32 v235, v230, v231
    ds_write_b128 v160, v[232:235] offset:5120
    ds_read_b64_tr_b16 v[240:241], v161 offset:5120
    ds_read_b64_tr_b16 v[242:243], v161 offset:5248
    v_pk_fma_f32 v[4:5], v[208:209], s[42:43], s[42:43] op_sel:[0,0,1] op_sel_hi:[1,0,1]
    v_pk_fma_f32 v[6:7], v[210:211], s[42:43], s[42:43] op_sel:[0,0,1] op_sel_hi:[1,0,1]
    v_pk_fma_f32 v[8:9], v[212:213], s[42:43], s[42:43] op_sel:[0,0,1] op_sel_hi:[1,0,1]
    v_pk_fma_f32 v[10:11], v[214:215], s[42:43], s[42:43] op_sel:[0,0,1] op_sel_hi:[1,0,1]
    v_pk_fma_f32 v[12:13], v[216:217], s[44:45], s[44:45] op_sel:[0,0,1] op_sel_hi:[1,0,1]
    v_pk_fma_f32 v[14:15], v[218:219], s[44:45], s[44:45] op_sel:[0,0,1] op_sel_hi:[1,0,1]
    v_pk_fma_f32 v[16:17], v[220:221], s[44:45], s[44:45] op_sel:[0,0,1] op_sel_hi:[1,0,1]
    v_pk_fma_f32 v[18:19], v[222:223], s[44:45], s[44:45] op_sel:[0,0,1] op_sel_hi:[1,0,1]
    s_waitcnt lgkmcnt(0)
    v_mfma_f32_16x16x32_f16 v[208:211], v[240:243], v[36:39], 0
    v_mfma_f32_16x16x32_f16 v[212:215], v[240:243], v[40:43], 0
    v_mfma_f32_16x16x32_f16 v[216:219], v[240:243], v[44:47], 0
    v_mfma_f32_16x16x32_f16 v[220:223], v[240:243], v[48:51], 0
    s_nop 4
    v_pk_mul_f32 v[232:233], v[208:209], v[52:53]
    v_pk_mul_f32 v[236:237], v[212:213], v[52:53]
    v_pk_fma_f32 v[232:233], v[212:213], v[60:61], v[232:233]
    v_pk_fma_f32 v[236:237], v[208:209], v[60:61], v[236:237] neg_lo:[1,0,0] neg_hi:[1,0,0]
    v_pk_mul_f32 v[234:235], v[210:211], v[54:55]
    v_pk_mul_f32 v[238:239], v[214:215], v[54:55]
    v_pk_fma_f32 v[234:235], v[214:215], v[62:63], v[234:235]
    v_pk_fma_f32 v[238:239], v[210:211], v[62:63], v[238:239] neg_lo:[1,0,0] neg_hi:[1,0,0]
    v_cvt_pk_f16_f32 v224, v232, v233
    v_cvt_pk_f16_f32 v225, v234, v235
    v_cvt_pk_f16_f32 v226, v236, v237
    v_cvt_pk_f16_f32 v227, v238, v239
    s_nop 1
    v_mfma_f32_16x16x32_f16 v[244:247], v[68:71], v[224:227], 0
    v_pk_mul_f32 v[232:233], v[216:217], v[56:57]
    v_pk_mul_f32 v[236:237], v[220:221], v[56:57]
    v_pk_fma_f32 v[232:233], v[220:221], v[64:65], v[232:233]
    v_pk_fma_f32 v[236:237], v[216:217], v[64:65], v[236:237] neg_lo:[1,0,0] neg_hi:[1,0,0]
    v_pk_mul_f32 v[234:235], v[218:219], v[58:59]
    v_pk_mul_f32 v[238:239], v[222:223], v[58:59]
    v_pk_fma_f32 v[234:235], v[222:223], v[66:67], v[234:235]
    v_pk_fma_f32 v[238:239], v[218:219], v[66:67], v[238:239] neg_lo:[1,0,0] neg_hi:[1,0,0]
    v_cvt_pk_f16_f32 v228, v232, v233
    v_cvt_pk_f16_f32 v229, v234, v235
    v_cvt_pk_f16_f32 v230, v236, v237
    v_cvt_pk_f16_f32 v231, v238, v239
    s_nop 1
    v_mfma_f32_16x16x32_f16 v[248:251], v[68:71], v[228:231], 0
    v_cvt_pk_f16_f32 v252, v244, v245
    v_cvt_pk_f16_f32 v253, v246, v247
    s_nop 5
    v_cvt_pk_f16_f32 v254, v248, v249
    v_cvt_pk_f16_f32 v255, v250, v251
    ds_write_b16 v164, v252 offset:0
    ds_write_b16_d16_hi v164, v252 offset:512
    ds_write_b16 v164, v253 offset:1024
    ds_write_b16_d16_hi v164, v253 offset:1536
    ds_write_b16 v165, v254 offset:0
    ds_write_b16_d16_hi v165, v254 offset:512
    ds_write_b16 v165, v255 offset:1024
    ds_write_b16_d16_hi v165, v255 offset:1536
    ds_write_b16_d16_hi v166, v253
    ds_write_b16_d16_hi v167, v253
    s_cmp_eq_u32 s69, 0
    s_cbranch_scc1 L_nopub_20
    s_lshl_b32 s27, s20, 12
    s_add_u32 s25, s27, 6291456
    s_cmp_gt_u32 s51, s50
    s_cbranch_scc1 L_pubv_21
    v_rcp_f32 v208, s42
    v_mov_b32 v209, s43
    v_mov_b32 v210, s42
    v_add_f32 v210, -1.0, v210
    v_subrev_f32 v211, s36, v209
    v_mul_f32 v212, v210, v208
    v_fma_f32 v214, -v212, v209, v211
    v_pk_fma_f32 v[216:217], v[4:5], v[212:213], v[214:215] op_sel_hi:[1,0,0]
    v_pk_fma_f32 v[218:219], v[6:7], v[212:213], v[214:215] op_sel_hi:[1,0,0]
    v_pk_fma_f32 v[220:221], v[8:9], v[212:213], v[214:215] op_sel_hi:[1,0,0]
    v_pk_fma_f32 v[222:223], v[10:11], v[212:213], v[214:215] op_sel_hi:[1,0,0]
    v_cvt_pk_bf16_f32 v224, v216, v217
    v_cvt_pk_bf16_f32 v225, v218, v219
    v_cvt_pk_bf16_f32 v226, v220, v221
    v_cvt_pk_bf16_f32 v227, v222, v223
    v_lshlrev_b32 v209, 4, v1
    v_lshlrev_b32 v210, 5, v1
    buffer_store_dwordx4 v[224:227], v209, s[4:7], s25 offen offset:128 sc1
    buffer_store_dwordx4 v[4:7], v210, s[4:7], s25 offen offset:1152 sc1
    buffer_store_dwordx4 v[8:11], v210, s[4:7], s25 offen offset:1168 sc1
    s_branch L_pubj_22
L_pubv_21:
    v_rcp_f32 v208, s44
    v_mov_b32 v209, s45
    v_mov_b32 v210, s44
    v_add_f32 v210, -1.0, v210
    v_subrev_f32 v211, s38, v209
    v_mul_f32 v212, v210, v208
    v_fma_f32 v214, -v212, v209, v211
    v_pk_fma_f32 v[216:217], v[12:13], v[212:213], v[214:215] op_sel_hi:[1,0,0]
    v_pk_fma_f32 v[218:219], v[14:15], v[212:213], v[214:215] op_sel_hi:[1,0,0]
    v_pk_fma_f32 v[220:221], v[16:17], v[212:213], v[214:215] op_sel_hi:[1,0,0]
    v_pk_fma_f32 v[222:223], v[18:19], v[212:213], v[214:215] op_sel_hi:[1,0,0]
    v_mov_b32_dpp v228, v216 wave_rol:1 row_mask:0xf bank_mask:0xf
    v_mov_b32_dpp v232, v12 wave_rol:1 row_mask:0xf bank_mask:0xf
    v_cvt_pk_bf16_f32 v225, v222, v221
    v_cvt_pk_bf16_f32 v226, v220, v219
    v_cvt_pk_bf16_f32 v227, v218, v217
    v_cvt_pk_bf16_f32 v224, v228, v223
    v_mov_b32 v233, v19
    v_mov_b32 v234, v18
    v_mov_b32 v235, v17
    v_mov_b32 v236, v16
    v_mov_b32 v237, v15
    v_mov_b32 v238, v14
    v_mov_b32 v239, v13
    v_lshlrev_b32 v209, 4, v1
    v_sub_u32 v209, 1008, v209
    v_lshlrev_b32 v210, 1, v209
    buffer_store_dwordx4 v[224:227], v209, s[4:7], s25 offen offset:128 sc1
    buffer_store_dwordx4 v[232:235], v210, s[4:7], s25 offen offset:1152 sc1
    buffer_store_dwordx4 v[236:239], v210, s[4:7], s25 offen offset:1168 sc1
L_pubj_22:
L_nopub_20:
    s_waitcnt lgkmcnt(0)
    s_barrier
    ds_read_b128 v[208:211], v183 offset:13312
    s_mov_b32 s25, 4194304
    s_waitcnt lgkmcnt(0)
    buffer_store_dwordx4 v[208:211], v178, s[4:7], s25 offen sc1
    s_mov_b32 s25, 6291456
    buffer_load_dword v185, v180, s[4:7], s25 offen  sc1
    s_cmp_ge_u32 s68, 172
    s_cbranch_scc1 L_nosetup_23
    v_and_b32 v232, 3, v2
    v_lshrrev_b32 v233, 2, v2
    v_lshl_add_u32 v233, v3, 3, v233
    s_lshl_b32 s27, s21, 7
    v_add_u32 v233, s27, v233
    v_lshlrev_b32 v233, 4, v233
    v_and_b32 v235, 1, v232
    v_lshl_add_u32 v233, v235, 3, v233
    v_lshrrev_b32 v235, 1, v232
    v_lshl_add_u32 v233, v235, 13, v233
    v_lshlrev_b32 v234, 2, v0
    s_barrier
    ds_read_b64_tr_b16 v[128:129], v233 offset:27776
    ds_read_b64_tr_b16 v[130:131], v233 offset:27840
    ds_read_b64_tr_b16 v[132:133], v233 offset:28288
    ds_read_b64_tr_b16 v[134:135], v233 offset:28352
    ds_read_b64_tr_b16 v[136:137], v233 offset:28800
    ds_read_b64_tr_b16 v[138:139], v233 offset:28864
    ds_read_b64_tr_b16 v[140:141], v233 offset:29312
    ds_read_b64_tr_b16 v[142:143], v233 offset:29376
    ds_read_b32 v236, v234 offset:44160
    ds_read_b32 v237, v234 offset:45184
    ds_read_b32 v238, v234 offset:46208
    ds_read_b32 v239, v234 offset:47232
    ds_read_b32 v240, v234 offset:48256
    ds_read_b32 v241, v234 offset:49280
    ds_read_b32 v242, v234 offset:50304
    ds_read_b32 v243, v234 offset:51328
    s_waitcnt lgkmcnt(0)
    v_lshlrev_b32 v144, 16, v236
    v_and_b32 v145, 0xffff0000, v236
    v_lshlrev_b32 v146, 16, v237
    v_and_b32 v147, 0xffff0000, v237
    v_lshlrev_b32 v148, 16, v238
    v_and_b32 v149, 0xffff0000, v238
    v_lshlrev_b32 v150, 16, v239
    v_and_b32 v151, 0xffff0000, v239
    v_lshlrev_b32 v152, 16, v240
    v_and_b32 v153, 0xffff0000, v240
    v_lshlrev_b32 v154, 16, v241
    v_and_b32 v155, 0xffff0000, v241
    v_lshlrev_b32 v156, 16, v242
    v_and_b32 v157, 0xffff0000, v242
    v_lshlrev_b32 v158, 16, v243
    v_and_b32 v159, 0xffff0000, v243
L_nosetup_23:
    s_cmp_lg_u32 s22, 0
    s_cbranch_scc1 L_nok_24
    v_rcp_f32 v252, s42
    v_mov_b32 v253, s47
    v_mul_f32 v252, s46, v252
    v_fma_f32 v253, -v252, s43, v253
    v_readfirstlane_b32 s54, v252
    v_readfirstlane_b32 s55, v253
    v_rcp_f32 v252, s44
    v_mov_b32 v253, s49
    v_mul_f32 v252, s48, v252
    v_fma_f32 v253, -v252, s45, v253
    v_readfirstlane_b32 s56, v252
    v_readfirstlane_b32 s57, v253
    v_pk_fma_f32 v[208:209], v[4:5], s[54:55], s[54:55] op_sel:[0,0,1] op_sel_hi:[1,0,1]
    v_pk_fma_f32 v[210:211], v[6:7], s[54:55], s[54:55] op_sel:[0,0,1] op_sel_hi:[1,0,1]
    v_pk_fma_f32 v[212:213], v[8:9], s[54:55], s[54:55] op_sel:[0,0,1] op_sel_hi:[1,0,1]
    v_pk_fma_f32 v[214:215], v[10:11], s[54:55], s[54:55] op_sel:[0,0,1] op_sel_hi:[1,0,1]
    v_pk_fma_f32 v[216:217], v[12:13], s[56:57], s[56:57] op_sel:[0,0,1] op_sel_hi:[1,0,1]
    v_pk_fma_f32 v[218:219], v[14:15], s[56:57], s[56:57] op_sel:[0,0,1] op_sel_hi:[1,0,1]
    v_pk_fma_f32 v[220:221], v[16:17], s[56:57], s[56:57] op_sel:[0,0,1] op_sel_hi:[1,0,1]
    v_pk_fma_f32 v[222:223], v[18:19], s[56:57], s[56:57] op_sel:[0,0,1] op_sel_hi:[1,0,1]
    v_mov_b32_dpp v228, v208 wave_rol:1 row_mask:0xf bank_mask:0xf
    v_cvt_pk_f16_f32 v225, v214, v213
    v_cvt_pk_f16_f32 v226, v212, v211
    v_cvt_pk_f16_f32 v227, v210, v209
    v_cvt_pk_f16_f32 v224, v228, v215
    ds_write_b128 v162, v[224:227]
    v_cvt_pk_f16_f32 v232, v216, v217
    v_cvt_pk_f16_f32 v233, v218, v219
    v_cvt_pk_f16_f32 v234, v220, v221
    v_cvt_pk_f16_f32 v235, v222, v223
    ds_write_b128 v160, v[232:235] offset:5120
    ds_read_b64_tr_b16 v[240:241], v161 offset:9216
    ds_read_b64_tr_b16 v[248:249], v161 offset:5120
    ds_read_b64_tr_b16 v[242:243], v161 offset:9344
    ds_read_b64_tr_b16 v[250:251], v161 offset:5248
    s_waitcnt lgkmcnt(0)
    v_pk_add_f16 v240, v240, v248 neg_lo:[0,1] neg_hi:[0,1]
    v_pk_add_f16 v241, v241, v249 neg_lo:[0,1] neg_hi:[0,1]
    v_pk_add_f16 v242, v242, v250 neg_lo:[0,1] neg_hi:[0,1]
    v_pk_add_f16 v243, v243, v251 neg_lo:[0,1] neg_hi:[0,1]
    s_nop 1
    v_mfma_f32_16x16x32_f16 v[208:211], v[240:243], v[36:39], 0
    v_mfma_f32_16x16x32_f16 v[212:215], v[240:243], v[40:43], 0
    v_mfma_f32_16x16x32_f16 v[216:219], v[240:243], v[44:47], 0
    v_mfma_f32_16x16x32_f16 v[220:223], v[240:243], v[48:51], 0
    s_nop 4
    v_pk_mul_f32 v[232:233], v[208:209], v[52:53]
    v_pk_mul_f32 v[236:237], v[212:213], v[52:53]
    v_pk_fma_f32 v[232:233], v[212:213], v[60:61], v[232:233]
    v_pk_fma_f32 v[236:237], v[208:209], v[60:61], v[236:237] neg_lo:[1,0,0] neg_hi:[1,0,0]
    v_pk_mul_f32 v[234:235], v[210:211], v[54:55]
    v_pk_mul_f32 v[238:239], v[214:215], v[54:55]
    v_pk_fma_f32 v[234:235], v[214:215], v[62:63], v[234:235]
    v_pk_fma_f32 v[238:239], v[210:211], v[62:63], v[238:239] neg_lo:[1,0,0] neg_hi:[1,0,0]
    v_cvt_pk_f16_f32 v224, v232, v233
    v_cvt_pk_f16_f32 v225, v234, v235
    v_cvt_pk_f16_f32 v226, v236, v237
    v_cvt_pk_f16_f32 v227, v238, v239
    s_nop 1
    v_mfma_f32_16x16x32_f16 v[244:247], v[68:71], v[224:227], 0
    v_pk_mul_f32 v[232:233], v[216:217], v[56:57]
    v_pk_mul_f32 v[236:237], v[220:221], v[56:57]
    v_pk_fma_f32 v[232:233], v[220:221], v[64:65], v[232:233]
    v_pk_fma_f32 v[236:237], v[216:217], v[64:65], v[236:237] neg_lo:[1,0,0] neg_hi:[1,0,0]
    v_pk_mul_f32 v[234:235], v[218:219], v[58:59]
    v_pk_mul_f32 v[238:239], v[222:223], v[58:59]
    v_pk_fma_f32 v[234:235], v[222:223], v[66:67], v[234:235]
    v_pk_fma_f32 v[238:239], v[218:219], v[66:67], v[238:239] neg_lo:[1,0,0] neg_hi:[1,0,0]
    v_cvt_pk_f16_f32 v228, v232, v233
    v_cvt_pk_f16_f32 v229, v234, v235
    v_cvt_pk_f16_f32 v230, v236, v237
    v_cvt_pk_f16_f32 v231, v238, v239
    s_nop 1
    v_mfma_f32_16x16x32_f16 v[248:251], v[68:71], v[228:231], 0
    v_mul_f32 v244, 0x3d800000, v244
    v_mul_f32 v245, 0x3d800000, v245
    v_mul_f32 v246, 0x3d800000, v246
    v_mul_f32 v247, 0x3d800000, v247
    s_nop 3
    v_mul_f32 v248, 0x3d800000, v248
    v_mul_f32 v249, 0x3d800000, v249
    v_mul_f32 v250, 0x3d800000, v250
    v_mul_f32 v251, 0x3d800000, v251
    v_cvt_pk_f16_f32 v252, v244, v245
    v_cvt_pk_f16_f32 v253, v246, v247
    v_cvt_pk_f16_f32 v254, v248, v249
    v_cvt_pk_f16_f32 v255, v250, v251
    v_lshl_add_u32 v208, v3, 7, v2
    v_lshlrev_b32 v208, 1, v208
    v_sub_u32 v209, 800, v208
    v_mov_b32 v210, 512
    s_mov_b32 exec_lo, -1
    s_mov_b32 exec_hi, 0
    ds_write_b16 v208, v252 offset:26048
    ds_write_b16 v209, v252 offset:26272
    ds_write_b16_d16_hi v208, v252 offset:26112
    ds_write_b16_d16_hi v209, v252 offset:26208
    ds_write_b16 v208, v253 offset:26176
    ds_write_b16 v209, v253 offset:26144
    ds_write_b16_d16_hi v208, v253 offset:26240
    ds_write_b16_d16_hi v209, v253 offset:26080
    ds_write_b16 v208, v254 offset:26080
    ds_write_b16 v209, v254 offset:26240
    ds_write_b16_d16_hi v208, v254 offset:26144
    ds_write_b16_d16_hi v209, v254 offset:26176
    ds_write_b16 v208, v255 offset:26208
    ds_write_b16 v209, v255 offset:26112
    ds_write_b16_d16_hi v208, v255 offset:26272
    ds_write_b16_d16_hi v209, v255 offset:26048
    s_mov_b32 exec_lo, 0
    s_mov_b32 exec_hi, 0x00010000
    ds_write_b16_d16_hi v210, v253 offset:26048
    s_mov_b64 exec, -1
    v_lshlrev_b32 v211, 4, v1
    s_waitcnt lgkmcnt(0)
    ds_read_b128 v[212:215], v211 offset:26048
    s_mov_b32 s25, 9445376
    s_waitcnt lgkmcnt(0)
    buffer_store_dwordx4 v[212:215], v211, s[4:7], s25 offen sc1
L_nok_24:
    s_waitcnt vmcnt(0)
    v_mov_b32 v208, v185
    s_mov_b32 s25, 6291456
    v_cmp_eq_u32 vcc, -1, v208
    s_cbranch_vccnz L_poll_25
L_ok_26:
    s_mov_b32 s25, 4194304
    buffer_load_dwordx4 v[248:251], v179, s[4:7], s25 offen  sc1
    v_max_u32_dpp v208, v208, v208 row_ror:8 row_mask:0xf bank_mask:0xf
    s_nop 1
    v_max_u32_dpp v208, v208, v208 row_ror:4 row_mask:0xf bank_mask:0xf
    s_nop 1
    v_max_u32_dpp v208, v208, v208 row_ror:2 row_mask:0xf bank_mask:0xf
    s_nop 1
    v_max_u32_dpp v208, v208, v208 row_ror:1 row_mask:0xf bank_mask:0xf
    v_mov_b32 v209, v208
    s_nop 1
    v_permlane16_swap_b32 v208, v209
    v_max_u32 v208, v208, v209
    v_mov_b32 v209, v208
    s_nop 1
    v_permlane32_swap_b32 v208, v209
    v_max_u32 v208, v208, v209
    s_lshl_b32 s27, s21, 2
    v_mov_b32 v209, s27
    ds_write_b32 v209, v208 offset:27424
    v_mov_b32 v209, 0
    s_waitcnt lgkmcnt(0)
    s_barrier
    ds_read_b128 v[212:215], v209 offset:27424
    s_waitcnt lgkmcnt(0)
    v_max3_u32 v212, v212, v213, v214
    v_max_u32 v212, v212, v215
    s_nop 0
    v_readfirstlane_b32 s52, v212
    s_nop 0
    s_and_b32 s31, s52, 2047
    s_lshr_b32 s27, s31, 2
    s_sub_u32 s28, 511, s27
    s_sub_u32 s29, 512, s27
    s_and_b32 s29, s29, 255
    s_and_b32 s32, s31, 3
    s_cmp_eq_u32 s32, 0
    s_cselect_b32 s28, s29, s28
    s_cmp_lt_u32 s31, 1024
    s_cselect_b32 s28, s27, s28
    s_lshl_b32 s32, s28, 12
    s_add_u32 s32, s32, 6291456
    s_cmp_ge_u32 s21, 2
    s_cbranch_scc1 L_nobase_27
    v_lshlrev_b32 v229, 5, v1
    buffer_load_dwordx4 v[192:195], v229, s[4:7], s32 offen offset:1152 sc1
    buffer_load_dwordx4 v[196:199], v229, s[4:7], s32 offen offset:1168 sc1
L_nobase_27:
    s_cmp_ge_u32 s68, 172
    s_cbranch_scc1 L_nox_28
    s_lshl_b32 s27, s21, 8
    v_lshlrev_b32 v228, 4, v3
    v_add_u32 v228, s27, v228
    buffer_load_dwordx4 v[208:211], v228, s[4:7], s32 offen offset:128 sc1
    buffer_load_dwordx4 v[212:215], v228, s[4:7], s32 offen offset:192 sc1
    buffer_load_dwordx4 v[216:219], v228, s[4:7], s32 offen offset:256 sc1
    buffer_load_dwordx4 v[220:223], v228, s[4:7], s32 offen offset:320 sc1
L_nox_28:
    s_and_b32 s27, s52, 0xfffff800
    s_or_b32 s27, s27, 0x400
    s_ashr_i32 s28, s27, 31
    s_not_b32 s28, s28
    s_or_b32 s28, s28, 0x80000000
    s_xor_b32 s27, s27, s28
    v_mov_b32 v185, 0xbfb8aa3b
    v_mul_f32 v185, s27, v185
    v_exp_f32 v185, v185
    s_nop 0
    v_add_f32 v185, 1.0, v185
    v_rcp_f32 v185, v185
    s_mul_i32 s27, s22, s31
    s_and_b32 s27, s27, 2047
    v_cvt_f32_u32 v187, s27
    v_mul_f32 v187, 0x3a000000, v187
    v_sin_f32 v188, v187
    v_cos_f32 v187, v187
    v_mul_f32 v188, 0x3d000000, v188
    v_mul_f32 v187, 0x3d000000, v187
    v_cvt_pk_f16_f32 v188, v188, v188
    v_cvt_pk_f16_f32 v187, v187, v187
    s_waitcnt vmcnt(0)
    s_cmp_ge_u32 s68, 172
    s_cbranch_scc1 L_noffn_29
    v_max3_u32 v186, v208, v209, v210
    v_max3_u32 v186, v186, v211, v212
    v_max3_u32 v186, v186, v213, v214
    v_max3_u32 v186, v186, v215, v216
    v_max3_u32 v186, v186, v217, v218
    v_max3_u32 v186, v186, v219, v220
    v_max3_u32 v186, v186, v221, v222
    v_max_u32 v186, v186, v223
    v_cmp_eq_u32 vcc, -1, v186
    s_cbranch_vccnz L_poll_30
L_ok_31:
    v_mfma_f32_16x16x32_bf16 v[224:227], v[128:131], v[208:211], 0
    v_mfma_f32_16x16x32_bf16 v[224:227], v[132:135], v[212:215], v[224:227]
    v_mfma_f32_16x16x32_bf16 v[224:227], v[136:139], v[216:219], v[224:227]
    v_mfma_f32_16x16x32_bf16 v[224:227], v[140:143], v[220:223], v[224:227]
    v_lshlrev_b32 v229, 6, v3
    s_lshl_b32 s27, s21, 2
    v_add_u32 v229, s27, v229
    v_and_b32 v230, 31, v1
    v_lshlrev_b32 v230, 2, v230
    s_mov_b32 exec_lo, 0x00010001
    s_mov_b32 exec_hi, 0x00010001
    s_nop 0
    ds_write_b32 v229, v224 offset:27136
    ds_write_b32 v229, v225 offset:27152
    ds_write_b32 v229, v226 offset:27168
    ds_write_b32 v229, v227 offset:27184
    s_mov_b64 exec, -1
    s_waitcnt lgkmcnt(0)
    s_barrier
    ds_read_b32 v220, v230 offset:27136
    ds_read_b32 v221, v230 offset:27264
    s_waitcnt lgkmcnt(0)
    v_add_f32_dpp v220, v220, v220 quad_perm:[1,0,3,2] row_mask:0xf bank_mask:0xf
    v_add_f32_dpp v221, v221, v221 quad_perm:[1,0,3,2] row_mask:0xf bank_mask:0xf
    s_nop 0
    v_add_f32_dpp v220, v220, v220 quad_perm:[2,3,0,1] row_mask:0xf bank_mask:0xf
    v_add_f32_dpp v221, v221, v221 quad_perm:[2,3,0,1] row_mask:0xf bank_mask:0xf
    v_mul_f32 v222, 0xbfb8aa3b, v220
    v_exp_f32 v222, v222
    v_mul_f32 v221, v221, v185
    v_add_f32 v222, 1.0, v222
    v_rcp_f32 v222, v222
    v_mul_f32 v220, v220, v221
    v_mul_f32 v220, v220, v222
    s_nop 0
    v_readlane_b32 s54, v220, 0
    v_readlane_b32 s55, v220, 4
    v_readlane_b32 s56, v220, 8
    v_readlane_b32 s57, v220, 12
    v_readlane_b32 s58, v220, 16
    v_readlane_b32 s59, v220, 20
    v_readlane_b32 s60, v220, 24
    v_readlane_b32 s61, v220, 28
    v_pk_mul_f32 v[224:225], v[144:145], s[54:55] op_sel_hi:[1,0]
    v_pk_fma_f32 v[224:225], v[146:147], s[54:55], v[224:225] op_sel:[0,1,0] op_sel_hi:[1,1,1]
    v_pk_fma_f32 v[224:225], v[148:149], s[56:57], v[224:225] op_sel_hi:[1,0,1]
    v_pk_fma_f32 v[224:225], v[150:151], s[56:57], v[224:225] op_sel:[0,1,0] op_sel_hi:[1,1,1]
    v_pk_fma_f32 v[224:225], v[152:153], s[58:59], v[224:225] op_sel_hi:[1,0,1]
    v_pk_fma_f32 v[224:225], v[154:155], s[58:59], v[224:225] op_sel:[0,1,0] op_sel_hi:[1,1,1]
    v_pk_fma_f32 v[224:225], v[156:157], s[60:61], v[224:225] op_sel_hi:[1,0,1]
    v_pk_fma_f32 v[224:225], v[158:159], s[60:61], v[224:225] op_sel:[0,1,0] op_sel_hi:[1,1,1]
    s_mov_b32 s25, 8388608
    buffer_store_dwordx2 v[224:225], v181, s[4:7], s25 offen sc1
L_noffn_29:
    s_mov_b32 s25, 4194304
    v_max3_u32 v186, v248, v249, v250
    v_max_u32 v186, v186, v251
    v_cmp_eq_u32 vcc, -1, v186
    s_cbranch_vccnz L_poll_32
L_ok_33:
    s_bitcmp0_b32 s20, 3
    s_cbranch_scc1 L_nosw_34
    v_swap_b32 v248, v250
    v_swap_b32 v249, v251
L_nosw_34:
    ds_write_b16 v168, v248
    ds_write_b16_d16_hi v168, v248 offset:16
    ds_write_b16 v168, v249 offset:32
    ds_write_b16_d16_hi v168, v249 offset:48
    ds_write_b16 v169, v250
    ds_write_b16_d16_hi v170, v250 offset:16
    ds_write_b16 v170, v251 offset:32
    ds_write_b16_d16_hi v170, v251 offset:48
    s_waitcnt lgkmcnt(0)
    s_barrier
    ds_read_b128 v[208:211], v163 offset:0
    ds_read_b128 v[212:215], v163 offset:1088
    ds_read_b128 v[216:219], v163 offset:2208
    ds_read_b128 v[220:223], v163 offset:3296
    s_waitcnt lgkmcnt(3)
    v_mfma_f32_16x16x32_f16 v[224:227], v[208:211], v[72:75], 0
    s_waitcnt lgkmcnt(2)
    v_mfma_f32_16x16x32_f16 v[224:227], v[212:215], v[76:79], v[224:227]
    s_waitcnt lgkmcnt(1)
    v_mfma_f32_16x16x32_f16 v[228:231], v[216:219], v[72:75], 0
    s_waitcnt lgkmcnt(0)
    v_mfma_f32_16x16x32_f16 v[228:231], v[220:223], v[76:79], v[228:231]
    s_nop 3
    v_mov_b32_dpp v232, v224 row_ror:8 row_mask:0xf bank_mask:0xf
    v_mov_b32_dpp v233, v225 row_ror:8 row_mask:0xf bank_mask:0xf
    v_mov_b32_dpp v234, v226 row_ror:8 row_mask:0xf bank_mask:0xf
    v_mov_b32_dpp v235, v227 row_ror:8 row_mask:0xf bank_mask:0xf
    v_pk_mul_f32 v[236:237], v[224:225], v[80:81]
    v_pk_mul_f32 v[240:241], v[224:225], v[88:89]
    v_pk_mul_f32 v[238:239], v[226:227], v[82:83]
    v_pk_mul_f32 v[242:243], v[226:227], v[90:91]
    v_pk_fma_f32 v[236:237], v[232:233], v[84:85], v[236:237]
    v_pk_fma_f32 v[240:241], v[232:233], v[92:93], v[240:241]
    v_pk_fma_f32 v[238:239], v[234:235], v[86:87], v[238:239]
    v_pk_fma_f32 v[242:243], v[234:235], v[94:95], v[242:243]
    v_cvt_pk_f16_f32 v208, v236, v237
    v_cvt_pk_f16_f32 v209, v238, v239
    v_cvt_pk_f16_f32 v210, v240, v241
    v_cvt_pk_f16_f32 v211, v242, v243
    s_nop 1
    v_mfma_f32_16x16x32_f16 v[216:219], v[112:115], v[208:211], 0
    v_mfma_f32_16x16x32_f16 v[220:223], v[120:123], v[208:211], 0
    v_mov_b32_dpp v232, v228 row_ror:8 row_mask:0xf bank_mask:0xf
    v_mov_b32_dpp v233, v229 row_ror:8 row_mask:0xf bank_mask:0xf
    v_mov_b32_dpp v234, v230 row_ror:8 row_mask:0xf bank_mask:0xf
    v_mov_b32_dpp v235, v231 row_ror:8 row_mask:0xf bank_mask:0xf
    v_pk_mul_f32 v[236:237], v[228:229], v[96:97]
    v_pk_mul_f32 v[240:241], v[228:229], v[104:105]
    v_pk_mul_f32 v[238:239], v[230:231], v[98:99]
    v_pk_mul_f32 v[242:243], v[230:231], v[106:107]
    v_pk_fma_f32 v[236:237], v[232:233], v[100:101], v[236:237]
    v_pk_fma_f32 v[240:241], v[232:233], v[108:109], v[240:241]
    v_pk_fma_f32 v[238:239], v[234:235], v[102:103], v[238:239]
    v_pk_fma_f32 v[242:243], v[234:235], v[110:111], v[242:243]
    v_cvt_pk_f16_f32 v212, v236, v237
    v_cvt_pk_f16_f32 v213, v238, v239
    v_cvt_pk_f16_f32 v214, v240, v241
    v_cvt_pk_f16_f32 v215, v242, v243
    s_nop 1
    v_mfma_f32_16x16x32_f16 v[216:219], v[116:119], v[212:215], v[216:219]
    v_mfma_f32_16x16x32_f16 v[220:223], v[124:127], v[212:215], v[220:223]
    s_nop 6
    v_cvt_pk_f16_f32 v224, v216, v217
    v_cvt_pk_f16_f32 v225, v218, v219
    ds_write_b16 v172, v224
    ds_write_b16_d16_hi v172, v224 offset:256
    v_cvt_pk_f16_f32 v226, v220, v221
    v_cvt_pk_f16_f32 v227, v222, v223
    ds_write_b16 v172, v225 offset:512
    ds_write_b16_d16_hi v172, v225 offset:768
    ds_write_b16 v174, v226
    ds_write_b16_d16_hi v173, v226 offset:512
    ds_write_b16 v173, v227 offset:256
    ds_write_b16_d16_hi v173, v227
    s_waitcnt lgkmcnt(0)
    s_barrier
    ds_read_b128 v[208:211], v183 offset:21952
    s_mov_b32 s25, 5242880
    s_waitcnt lgkmcnt(0)
    buffer_store_dwordx4 v[208:211], v178, s[4:7], s25 offen sc1
    s_sub_u32 s29, s20, 192
    s_bitcmp1_b32 s20, 0
    s_cselect_b32 s29, -1, s29
    s_lshr_b32 s29, s29, 1
    s_cmp_ge_u32 s29, 32
    s_cbranch_scc1 L_nored_35
    s_waitcnt vmcnt(0)
    v_lshrrev_b32 v228, 4, v0
    v_and_b32 v230, 15, v0
    v_lshlrev_b32 v230, 2, v230
    s_lshl_b32 s27, s29, 6
    v_add_u32 v233, s27, v230
    v_lshl_add_u32 v229, v228, 11, v233
    v_add_u32 v231, 327680, v229
    v_mov_b32 v232, 0x7f000000
    v_cmp_gt_u32 vcc, 12, v228
    s_nop 1
    v_cndmask_b32 v231, v232, v231, vcc
    s_mov_b32 s25, 8388608
    buffer_load_dword v208, v229, s[4:7], s25 offen  sc1
    s_mov_b32 s25, 8421376
    buffer_load_dword v209, v229, s[4:7], s25 offen  sc1
    s_mov_b32 s25, 8454144
    buffer_load_dword v210, v229, s[4:7], s25 offen  sc1
    s_mov_b32 s25, 8486912
    buffer_load_dword v211, v229, s[4:7], s25 offen  sc1
    s_mov_b32 s25, 8519680
    buffer_load_dword v212, v229, s[4:7], s25 offen  sc1
    s_mov_b32 s25, 8552448
    buffer_load_dword v213, v229, s[4:7], s25 offen  sc1
    s_mov_b32 s25, 8585216
    buffer_load_dword v214, v229, s[4:7], s25 offen  sc1
    s_mov_b32 s25, 8617984
    buffer_load_dword v215, v229, s[4:7], s25 offen  sc1
    s_mov_b32 s25, 8650752
    buffer_load_dword v216, v229, s[4:7], s25 offen  sc1
    s_mov_b32 s25, 8683520
    buffer_load_dword v217, v229, s[4:7], s25 offen  sc1
    s_mov_b32 s25, 8388608
    buffer_load_dword v218, v231, s[4:7], s25 offen  sc1
    s_waitcnt vmcnt(0)
    v_max3_u32 v186, v208, v209, v210
    v_max3_u32 v186, v186, v211, v212
    v_max3_u32 v186, v186, v213, v214
    v_max3_u32 v186, v186, v215, v216
    v_max3_u32 v186, v186, v217, v218
    v_cmp_eq_u32 vcc, -1, v186
    s_cbranch_vccnz L_poll_36
L_ok_37:
    v_add_f32 v208, v208, v218
    v_add_f32 v209, v209, v217
    v_add_f32 v210, v210, v216
    v_add_f32 v211, v211, v215
    v_add_f32 v212, v212, v214
    v_add_f32 v208, v208, v213
    v_add_f32 v209, v209, v212
    v_add_f32 v210, v210, v211
    v_add_f32 v208, v208, v210
    v_add_f32 v208, v208, v209
    v_mov_b32 v209, v208
    s_nop 1
    v_permlane16_swap_b32 v208, v209
    v_add_f32 v208, v208, v209
    v_mov_b32 v209, v208
    s_nop 1
    v_permlane32_swap_b32 v208, v209
    v_add_f32 v208, v208, v209
    s_lshl_b32 s27, s21, 2
    v_lshl_add_u32 v232, v230, 2, s27
    v_lshlrev_b32 v234, 2, v230
    s_mov_b64 exec, 0xffff
    ds_write_b32 v232, v208 offset:27456
    s_mov_b64 exec, -1
    s_waitcnt lgkmcnt(0)
    s_barrier
    s_cmp_lg_u32 s21, 0
    s_cbranch_scc1 L_nored_35
    ds_read_b128 v[236:239], v234 offset:27456
    s_waitcnt lgkmcnt(0)
    v_add_f32 v236, v236, v237
    v_add_f32 v238, v238, v239
    v_add_f32 v236, v236, v238
    s_mov_b32 s25, 9437184
    s_mov_b64 exec, 0xffff
    buffer_store_dword v236, v233, s[4:7], s25 offen sc1
    s_mov_b64 exec, -1
L_nored_35:
    s_cmp_ge_u32 s21, 2
    s_cbranch_scc1 L_nobase_38
    v_lshlrev_b32 v229, 5, v1
    v_max3_u32 v186, v192, v193, v194
    v_max3_u32 v186, v186, v195, v196
    v_max3_u32 v186, v186, v197, v198
    v_max_u32 v186, v186, v199
    v_cmp_eq_u32 vcc, -1, v186
    s_cbranch_vccnz L_poll_39
L_ok_40:
    v_readfirstlane_b32 s36, v192
    s_nop 1
    v_pk_add_f32 v[208:209], v[192:193], s[36:37] op_sel_hi:[1,0] neg_lo:[0,1] neg_hi:[0,1]
    v_pk_add_f32 v[210:211], v[194:195], s[36:37] op_sel_hi:[1,0] neg_lo:[0,1] neg_hi:[0,1]
    v_pk_add_f32 v[212:213], v[196:197], s[36:37] op_sel_hi:[1,0] neg_lo:[0,1] neg_hi:[0,1]
    v_pk_add_f32 v[214:215], v[198:199], s[36:37] op_sel_hi:[1,0] neg_lo:[0,1] neg_hi:[0,1]
    v_pk_add_f32 v[232:233], v[208:209], v[210:211]
    v_pk_mul_f32 v[234:235], v[208:209], v[208:209]
    v_pk_add_f32 v[236:237], v[212:213], v[214:215]
    v_pk_fma_f32 v[234:235], v[210:211], v[210:211], v[234:235]
    v_pk_add_f32 v[232:233], v[232:233], v[236:237]
    v_pk_fma_f32 v[234:235], v[212:213], v[212:213], v[234:235]
    v_pk_fma_f32 v[234:235], v[214:215], v[214:215], v[234:235]
    v_add_f32 v224, v232, v233
    v_add_f32 v225, v234, v235
    s_nop 0
    v_add_f32_dpp v224, v224, v224 row_ror:8 row_mask:0xf bank_mask:0xf
    v_add_f32_dpp v225, v225, v225 row_ror:8 row_mask:0xf bank_mask:0xf
    s_nop 0
    v_add_f32_dpp v224, v224, v224 row_ror:4 row_mask:0xf bank_mask:0xf
    v_add_f32_dpp v225, v225, v225 row_ror:4 row_mask:0xf bank_mask:0xf
    s_nop 0
    v_add_f32_dpp v224, v224, v224 row_ror:2 row_mask:0xf bank_mask:0xf
    v_add_f32_dpp v225, v225, v225 row_ror:2 row_mask:0xf bank_mask:0xf
    s_nop 0
    v_add_f32_dpp v224, v224, v224 row_ror:1 row_mask:0xf bank_mask:0xf
    v_add_f32_dpp v225, v225, v225 row_ror:1 row_mask:0xf bank_mask:0xf
    v_mov_b32 v226, v224
    v_mov_b32 v227, v225
    s_nop 0
    v_permlane16_swap_b32 v224, v226
    v_permlane16_swap_b32 v225, v227
    v_add_f32 v224, v224, v226
    v_add_f32 v225, v225, v227
    v_mov_b32 v226, v224
    v_mov_b32 v227, v225
    s_nop 0
    v_permlane32_swap_b32 v224, v226
    v_permlane32_swap_b32 v225, v227
    v_add_f32 v224, v224, v226
    v_add_f32 v225, v225, v227
    v_mul_f32 v248, 0x3b000000, v224
    v_mul_f32 v225, 0x3b000000, v225
    v_fma_f32 v249, -v248, v248, v225
    v_add_f32 v225, 0x3727c5ac, v249
    v_rsq_f32 v250, v225
    s_nop 0
    v_readfirstlane_b32 s46, v250
    v_mul_f32 v251, -v248, v250
    s_nop 0
    v_readfirstlane_b32 s47, v251
    s_nop 1
    v_mov_b32 v228, s47
    v_mov_b32 v229, s46
    v_fma_f32 v228, -v229, s36, v228
    s_mov_b32 s48, s46
    v_readfirstlane_b32 s49, v228
L_nobase_38:
    s_waitcnt vmcnt(0)
    s_bitcmp0_b32 s21, 0
    s_cbranch_scc1 L_nok_41
    v_lshlrev_b32 v224, 4, v1
    s_mov_b32 s29, 9445376
    buffer_load_dwordx4 v[220:223], v224, s[4:7], s29 offen  sc1
L_nok_41:
    s_mov_b32 s25, 5242880
    buffer_load_dwordx4 v[208:211], v179, s[4:7], s25 offen  sc1
    s_waitcnt vmcnt(0)
    v_max3_u32 v186, v208, v209, v210
    v_max_u32 v186, v186, v211
    v_cmp_eq_u32 vcc, -1, v186
    s_cbranch_vccnz L_poll_42
L_ok_43:
    ds_write_b16 v171, v208 offset:0
    ds_write_b16_d16_hi v171, v208 offset:1024
    ds_write_b16 v171, v209 offset:2048
    ds_write_b16_d16_hi v171, v209 offset:3072
    ds_write_b16 v182, v210 offset:0
    ds_write_b16_d16_hi v175, v210 offset:3072
    ds_write_b16 v175, v211 offset:2048
    ds_write_b16_d16_hi v175, v211 offset:1024
    s_cmp_lg_u32 s20, 0
    s_cbranch_scc1 L_not0_44
    ds_write_b16 v175, v208 offset:0
    ds_write_b16 v171, v210 offset:4096
L_not0_44:
    s_waitcnt lgkmcnt(0)
    s_barrier
    ds_read_b128 v[200:203], v160 offset:0
    s_cmp_lg_u32 s22, 0
    s_cbranch_scc1 L_yv_45
    ds_read_b128 v[204:207], v160 offset:4096
L_yv_45:
    s_bitcmp0_b32 s21, 0
    s_cbranch_scc1 L_nok2_46
    v_max3_u32 v186, v220, v221, v222
    v_max_u32 v186, v186, v223
    v_cmp_eq_u32 vcc, -1, v186
    s_cbranch_vccnz L_poll_47
L_ok_48:
    s_waitcnt lgkmcnt(0)
    v_pk_add_f16 v200, v200, v220
    v_pk_add_f16 v201, v201, v221
    v_pk_add_f16 v202, v202, v222
    v_pk_add_f16 v203, v203, v223
L_nok2_46:
    s_waitcnt lgkmcnt(0)
    v_lshl_add_u32 v168, v3, 7, v2
    v_lshlrev_b32 v209, 7, v3
    v_sub_u32 v209, 736, v209
    v_add_u32 v209, v209, v2
    v_cmp_gt_u32 vcc, 2, v3
    v_mov_b32 v169, 64
    v_mov_b32 v211, -64
    v_cndmask_b32 v168, v209, v168, vcc
    v_cndmask_b32 v169, v211, v169, vcc
    v_lshlrev_b32 v168, 1, v168
    s_lshl_b32 s27, s21, 10
    v_add_u32 v168, s27, v168
    v_lshlrev_b32 v252, 5, v1
    s_mov_b32 s25, 9437184
    s_cmp_lg_u32 s31, s23
    s_cbranch_scc1 L_notv_53
    v_sub_u32 v253, 2016, v252
    buffer_load_dwordx4 v[224:227], v253, s[4:7], s25 offen  sc1
    buffer_load_dwordx4 v[228:231], v253, s[4:7], s25 offen offset:16 sc1
    s_waitcnt vmcnt(0)
    v_max3_u32 v186, v224, v225, v226
    v_max3_u32 v186, v186, v227, v228
    v_max3_u32 v186, v186, v229, v230
    v_max_u32 v186, v186, v231
    v_cmp_eq_u32 vcc, -1, v186
    s_cbranch_vccnz L_poll_54
L_ok_55:
    v_mov_b32_dpp v254, v224 wave_ror:1 row_mask:0xf bank_mask:0xf
    v_add_f32 v13, v13, v231
    v_add_f32 v14, v14, v230
    v_add_f32 v15, v15, v229
    v_add_f32 v16, v16, v228
    v_add_f32 v17, v17, v227
    v_add_f32 v18, v18, v226
    v_add_f32 v19, v19, v225
    v_add_f32 v12, v12, v254
L_notv_53:
    s_cmp_lt_u32 s21, 2
    s_cbranch_scc1 L_fix_50
    s_cmp_lg_u32 s31, s22
    s_cbranch_scc1 L_fixj_49
    buffer_load_dwordx4 v[224:227], v252, s[4:7], s25 offen  sc1
    buffer_load_dwordx4 v[228:231], v252, s[4:7], s25 offen offset:16 sc1
    s_waitcnt vmcnt(0)
    v_max3_u32 v186, v224, v225, v226
    v_max3_u32 v186, v186, v227, v228
    v_max3_u32 v186, v186, v229, v230
    v_max_u32 v186, v186, v231
    v_cmp_eq_u32 vcc, -1, v186
    s_cbranch_vccnz L_poll_56
L_ok_57:
    s_cmp_lg_u32 s31, s22
    s_cbranch_scc1 L_nu_58
    v_pk_add_f32 v[4:5], v[4:5], v[224:225]
    v_pk_add_f32 v[6:7], v[6:7], v[226:227]
    v_pk_add_f32 v[8:9], v[8:9], v[228:229]
    v_pk_add_f32 v[10:11], v[10:11], v[230:231]
L_nu_58:
    s_branch L_fixj_49
L_fix_50:
    buffer_load_dwordx4 v[224:227], v252, s[4:7], s25 offen  sc1
    buffer_load_dwordx4 v[228:231], v252, s[4:7], s25 offen offset:16 sc1
    s_waitcnt vmcnt(0)
    v_max3_u32 v186, v224, v225, v226
    v_max3_u32 v186, v186, v227, v228
    v_max3_u32 v186, v186, v229, v230
    v_max_u32 v186, v186, v231
    v_cmp_eq_u32 vcc, -1, v186
    s_cbranch_vccnz L_poll_60
L_ok_61:
    s_cmp_lg_u32 s31, s22
    s_cbranch_scc1 L_nu_62
    v_pk_add_f32 v[4:5], v[4:5], v[224:225]
    v_pk_add_f32 v[6:7], v[6:7], v[226:227]
    v_pk_add_f32 v[8:9], v[8:9], v[228:229]
    v_pk_add_f32 v[10:11], v[10:11], v[230:231]
L_nu_62:
    v_pk_add_f32 v[224:225], v[192:193], v[224:225]
    v_pk_add_f32 v[226:227], v[194:195], v[226:227]
    v_pk_add_f32 v[228:229], v[196:197], v[228:229]
    v_pk_add_f32 v[230:231], v[198:199], v[230:231]
    v_readfirstlane_b32 s36, v224
    s_nop 1
    v_pk_add_f32 v[240:241], v[224:225], s[36:37] op_sel_hi:[1,0] neg_lo:[0,1] neg_hi:[0,1]
    v_pk_add_f32 v[242:243], v[226:227], s[36:37] op_sel_hi:[1,0] neg_lo:[0,1] neg_hi:[0,1]
    v_pk_add_f32 v[244:245], v[228:229], s[36:37] op_sel_hi:[1,0] neg_lo:[0,1] neg_hi:[0,1]
    v_pk_add_f32 v[246:247], v[230:231], s[36:37] op_sel_hi:[1,0] neg_lo:[0,1] neg_hi:[0,1]
    v_pk_add_f32 v[232:233], v[240:241], v[242:243]
    v_pk_mul_f32 v[234:235], v[240:241], v[240:241]
    v_pk_add_f32 v[236:237], v[244:245], v[246:247]
    v_pk_fma_f32 v[234:235], v[242:243], v[242:243], v[234:235]
    v_pk_add_f32 v[232:233], v[232:233], v[236:237]
    v_pk_fma_f32 v[234:235], v[244:245], v[244:245], v[234:235]
    v_pk_fma_f32 v[234:235], v[246:247], v[246:247], v[234:235]
    v_add_f32 v216, v232, v233
    v_add_f32 v217, v234, v235
    s_nop 0
    v_add_f32_dpp v216, v216, v216 row_ror:8 row_mask:0xf bank_mask:0xf
    v_add_f32_dpp v217, v217, v217 row_ror:8 row_mask:0xf bank_mask:0xf
    s_nop 0
    v_add_f32_dpp v216, v216, v216 row_ror:4 row_mask:0xf bank_mask:0xf
    v_add_f32_dpp v217, v217, v217 row_ror:4 row_mask:0xf bank_mask:0xf
    s_nop 0
    v_add_f32_dpp v216, v216, v216 row_ror:2 row_mask:0xf bank_mask:0xf
    v_add_f32_dpp v217, v217, v217 row_ror:2 row_mask:0xf bank_mask:0xf
    s_nop 0
    v_add_f32_dpp v216, v216, v216 row_ror:1 row_mask:0xf bank_mask:0xf
    v_add_f32_dpp v217, v217, v217 row_ror:1 row_mask:0xf bank_mask:0xf
    v_mov_b32 v218, v216
    v_mov_b32 v219, v217
    s_nop 0
    v_permlane16_swap_b32 v216, v218
    v_permlane16_swap_b32 v217, v219
    v_add_f32 v216, v216, v218
    v_add_f32 v217, v217, v219
    v_mov_b32 v218, v216
    v_mov_b32 v219, v217
    s_nop 0
    v_permlane32_swap_b32 v216, v218
    v_permlane32_swap_b32 v217, v219
    v_add_f32 v216, v216, v218
    v_add_f32 v217, v217, v219
    v_mul_f32 v248, 0x3b000000, v216
    v_mul_f32 v217, 0x3b000000, v217
    v_fma_f32 v249, -v248, v248, v217
    v_add_f32 v217, 0x3727c5ac, v249
    v_rsq_f32 v250, v217
    s_nop 0
    v_mul_f32 v251, -v248, v250
    v_subrev_f32 v251, s49, v251
    v_readfirstlane_b32 s46, v250
    v_readfirstlane_b32 s47, v251
    s_nop 1
    v_pk_fma_f32 v[208:209], v[240:241], s[46:47], s[46:47] op_sel:[0,0,1] op_sel_hi:[1,0,1]
    v_pk_fma_f32 v[210:211], v[242:243], s[46:47], s[46:47] op_sel:[0,0,1] op_sel_hi:[1,0,1]
    v_pk_fma_f32 v[212:213], v[244:245], s[46:47], s[46:47] op_sel:[0,0,1] op_sel_hi:[1,0,1]
    v_pk_fma_f32 v[214:215], v[246:247], s[46:47], s[46:47] op_sel:[0,0,1] op_sel_hi:[1,0,1]
    v_pk_fma_f32 v[208:209], v[192:193], s[48:49], v[208:209] op_sel_hi:[1,0,1] neg_lo:[0,1,0] neg_hi:[0,1,0]
    v_pk_fma_f32 v[210:211], v[194:195], s[48:49], v[210:211] op_sel_hi:[1,0,1] neg_lo:[0,1,0] neg_hi:[0,1,0]
    v_pk_fma_f32 v[212:213], v[196:197], s[48:49], v[212:213] op_sel_hi:[1,0,1] neg_lo:[0,1,0] neg_hi:[0,1,0]
    v_pk_fma_f32 v[214:215], v[198:199], s[48:49], v[214:215] op_sel_hi:[1,0,1] neg_lo:[0,1,0] neg_hi:[0,1,0]
    v_cvt_pk_f16_f32 v232, v208, v209
    v_cvt_pk_f16_f32 v233, v210, v211
    v_cvt_pk_f16_f32 v234, v212, v213
    v_cvt_pk_f16_f32 v235, v214, v215
    ds_write_b128 v160, v[232:235] offset:5120
    v_mov_b32_dpp v252, v208 wave_rol:1 row_mask:0xf bank_mask:0xf
    v_cvt_pk_f16_f32 v249, v214, v213
    v_cvt_pk_f16_f32 v250, v212, v211
    v_cvt_pk_f16_f32 v251, v210, v209
    v_cvt_pk_f16_f32 v248, v252, v215
    ds_write_b128 v162, v[248:251]
    s_mov_b32 s27, 0x3c003c00
    s_cmp_eq_u32 s21, 0
    s_cselect_b32 s69, s27, 0xbc00bc00
    ds_read_b64_tr_b16 v[240:241], v161 offset:5120
    ds_read_b64_tr_b16 v[248:249], v161 offset:9216
    ds_read_b64_tr_b16 v[242:243], v161 offset:5248
    ds_read_b64_tr_b16 v[250:251], v161 offset:9344
    s_waitcnt lgkmcnt(0)
    v_pk_fma_f16 v240, v248, s69, v240
    v_pk_fma_f16 v241, v249, s69, v241
    v_pk_fma_f16 v242, v250, s69, v242
    v_pk_fma_f16 v243, v251, s69, v243
    s_nop 1
    v_mfma_f32_16x16x32_f16 v[208:211], v[240:243], v[36:39], 0
    v_mfma_f32_16x16x32_f16 v[212:215], v[240:243], v[40:43], 0
    v_mfma_f32_16x16x32_f16 v[216:219], v[240:243], v[44:47], 0
    v_mfma_f32_16x16x32_f16 v[220:223], v[240:243], v[48:51], 0
    s_nop 4
    v_pk_mul_f32 v[232:233], v[208:209], v[52:53]
    v_pk_mul_f32 v[236:237], v[212:213], v[52:53]
    v_pk_fma_f32 v[232:233], v[212:213], v[60:61], v[232:233]
    v_pk_fma_f32 v[236:237], v[208:209], v[60:61], v[236:237] neg_lo:[1,0,0] neg_hi:[1,0,0]
    v_pk_mul_f32 v[234:235], v[210:211], v[54:55]
    v_pk_mul_f32 v[238:239], v[214:215], v[54:55]
    v_pk_fma_f32 v[234:235], v[214:215], v[62:63], v[234:235]
    v_pk_fma_f32 v[238:239], v[210:211], v[62:63], v[238:239] neg_lo:[1,0,0] neg_hi:[1,0,0]
    v_cvt_pk_f16_f32 v224, v232, v233
    v_cvt_pk_f16_f32 v225, v234, v235
    v_cvt_pk_f16_f32 v226, v236, v237
    v_cvt_pk_f16_f32 v227, v238, v239
    s_nop 1
    v_mfma_f32_16x16x32_f16 v[244:247], v[68:71], v[224:227], 0
    v_pk_mul_f32 v[232:233], v[216:217], v[56:57]
    v_pk_mul_f32 v[236:237], v[220:221], v[56:57]
    v_pk_fma_f32 v[232:233], v[220:221], v[64:65], v[232:233]
    v_pk_fma_f32 v[236:237], v[216:217], v[64:65], v[236:237] neg_lo:[1,0,0] neg_hi:[1,0,0]
    v_pk_mul_f32 v[234:235], v[218:219], v[58:59]
    v_pk_mul_f32 v[238:239], v[222:223], v[58:59]
    v_pk_fma_f32 v[234:235], v[222:223], v[66:67], v[234:235]
    v_pk_fma_f32 v[238:239], v[218:219], v[66:67], v[238:239] neg_lo:[1,0,0] neg_hi:[1,0,0]
    v_cvt_pk_f16_f32 v228, v232, v233
    v_cvt_pk_f16_f32 v229, v234, v235
    v_cvt_pk_f16_f32 v230, v236, v237
    v_cvt_pk_f16_f32 v231, v238, v239
    s_nop 1
    v_mfma_f32_16x16x32_f16 v[248:251], v[68:71], v[228:231], 0
    v_cvt_pk_f16_f32 v252, v244, v245
    v_cvt_pk_f16_f32 v253, v246, v247
    s_nop 5
    v_cvt_pk_f16_f32 v254, v248, v249
    v_cvt_pk_f16_f32 v255, v250, v251
    ds_write_b16 v168, v252 offset:11264
    ds_write_b16 v168, v254 offset:11296
    v_add_u32 v168, v168, v169
    ds_write_b16_d16_hi v168, v252 offset:11264
    ds_write_b16_d16_hi v168, v254 offset:11296
    v_add_u32 v168, v168, v169
    ds_write_b16 v168, v253 offset:11264
    ds_write_b16 v168, v255 offset:11296
    v_add_u32 v168, v168, v169
    ds_write_b16_d16_hi v168, v253 offset:11264
    ds_write_b16_d16_hi v168, v255 offset:11296
L_fixj_49:
    s_waitcnt lgkmcnt(0)
    s_barrier
    v_lshlrev_b32 v208, 4, v1
    ds_read_b128 v[224:227], v208 offset:11264
    ds_read_b128 v[228:231], v208 offset:12288
    s_waitcnt lgkmcnt(1)
    v_pk_fma_f16 v200, v224, v187, v200
    v_pk_fma_f16 v201, v225, v187, v201
    v_pk_fma_f16 v202, v226, v187, v202
    v_pk_fma_f16 v203, v227, v187, v203
    s_cmp_lg_u32 s22, 0
    s_cbranch_scc1 L_fsp_64
    s_mov_b32 s27, 0x28002800
    s_bitcmp0_b32 s31, 0
    s_cselect_b32 s27, s27, 0xa800a800
    v_pk_fma_f16 v204, v224, s27, v204
    v_pk_fma_f16 v205, v225, s27, v205
    v_pk_fma_f16 v206, v226, s27, v206
    v_pk_fma_f16 v207, v227, s27, v207
L_fsp_64:
    s_waitcnt lgkmcnt(0)
    v_pk_fma_f16 v200, v228, v188, v200
    v_pk_fma_f16 v201, v229, v188, v201
    v_pk_fma_f16 v202, v230, v188, v202
    v_pk_fma_f16 v203, v231, v188, v203
    s_cmp_eq_u32 s22, 0
    s_cbranch_scc1 L_ysp_65
    v_fma_mix_f32 v4, v200, s30, v4 op_sel:[0,0,0] op_sel_hi:[1,0,0]
    v_fma_mix_f32 v5, v200, s30, v5 op_sel:[1,0,0] op_sel_hi:[1,0,0]
    v_fma_mix_f32 v6, v201, s30, v6 op_sel:[0,0,0] op_sel_hi:[1,0,0]
    v_fma_mix_f32 v7, v201, s30, v7 op_sel:[1,0,0] op_sel_hi:[1,0,0]
    v_fma_mix_f32 v8, v202, s30, v8 op_sel:[0,0,0] op_sel_hi:[1,0,0]
    v_fma_mix_f32 v9, v202, s30, v9 op_sel:[1,0,0] op_sel_hi:[1,0,0]
    v_fma_mix_f32 v10, v203, s30, v10 op_sel:[0,0,0] op_sel_hi:[1,0,0]
    v_fma_mix_f32 v11, v203, s30, v11 op_sel:[1,0,0] op_sel_hi:[1,0,0]
    v_fma_mix_f32 v12, v200, s30, v12 op_sel:[0,0,0] op_sel_hi:[1,0,0]
    v_fma_mix_f32 v13, v200, s30, v13 op_sel:[1,0,0] op_sel_hi:[1,0,0]
    v_fma_mix_f32 v14, v201, s30, v14 op_sel:[0,0,0] op_sel_hi:[1,0,0]
    v_fma_mix_f32 v15, v201, s30, v15 op_sel:[1,0,0] op_sel_hi:[1,0,0]
    v_fma_mix_f32 v16, v202, s30, v16 op_sel:[0,0,0] op_sel_hi:[1,0,0]
    v_fma_mix_f32 v17, v202, s30, v17 op_sel:[1,0,0] op_sel_hi:[1,0,0]
    v_fma_mix_f32 v18, v203, s30, v18 op_sel:[0,0,0] op_sel_hi:[1,0,0]
    v_fma_mix_f32 v19, v203, s30, v19 op_sel:[1,0,0] op_sel_hi:[1,0,0]
L_yj_66:
    v_readfirstlane_b32 s36, v4
    v_readfirstlane_b32 s38, v12
    s_nop 0
    v_pk_add_f32 v[208:209], v[4:5], s[36:37] op_sel_hi:[1,0] neg_lo:[0,1] neg_hi:[0,1]
    v_pk_add_f32 v[210:211], v[6:7], s[36:37] op_sel_hi:[1,0] neg_lo:[0,1] neg_hi:[0,1]
    v_pk_add_f32 v[212:213], v[8:9], s[36:37] op_sel_hi:[1,0] neg_lo:[0,1] neg_hi:[0,1]
    v_pk_add_f32 v[214:215], v[10:11], s[36:37] op_sel_hi:[1,0] neg_lo:[0,1] neg_hi:[0,1]
    v_pk_add_f32 v[232:233], v[208:209], v[210:211]
    v_pk_mul_f32 v[234:235], v[208:209], v[208:209]
    v_pk_add_f32 v[236:237], v[212:213], v[214:215]
    v_pk_mul_f32 v[238:239], v[208:209], v[20:21]
    v_pk_fma_f32 v[234:235], v[210:211], v[210:211], v[234:235]
    v_pk_fma_f32 v[238:239], v[210:211], v[22:23], v[238:239]
    v_pk_add_f32 v[232:233], v[232:233], v[236:237]
    v_pk_fma_f32 v[234:235], v[212:213], v[212:213], v[234:235]
    v_pk_fma_f32 v[238:239], v[212:213], v[24:25], v[238:239]
    v_pk_fma_f32 v[234:235], v[214:215], v[214:215], v[234:235]
    v_pk_fma_f32 v[238:239], v[214:215], v[26:27], v[238:239]
    v_add_f32 v224, v232, v233
    v_add_f32 v225, v234, v235
    v_add_f32 v226, v238, v239
    v_pk_add_f32 v[216:217], v[12:13], s[38:39] op_sel_hi:[1,0] neg_lo:[0,1] neg_hi:[0,1]
    v_pk_add_f32 v[218:219], v[14:15], s[38:39] op_sel_hi:[1,0] neg_lo:[0,1] neg_hi:[0,1]
    v_pk_add_f32 v[220:221], v[16:17], s[38:39] op_sel_hi:[1,0] neg_lo:[0,1] neg_hi:[0,1]
    v_pk_add_f32 v[222:223], v[18:19], s[38:39] op_sel_hi:[1,0] neg_lo:[0,1] neg_hi:[0,1]
    v_pk_add_f32 v[240:241], v[216:217], v[218:219]
    v_pk_mul_f32 v[242:243], v[216:217], v[216:217]
    v_pk_add_f32 v[244:245], v[220:221], v[222:223]
    v_pk_mul_f32 v[246:247], v[216:217], v[28:29]
    v_pk_fma_f32 v[242:243], v[218:219], v[218:219], v[242:243]
    v_pk_fma_f32 v[246:247], v[218:219], v[30:31], v[246:247]
    v_pk_add_f32 v[240:241], v[240:241], v[244:245]
    v_pk_fma_f32 v[242:243], v[220:221], v[220:221], v[242:243]
    v_pk_fma_f32 v[246:247], v[220:221], v[32:33], v[246:247]
    v_pk_fma_f32 v[242:243], v[222:223], v[222:223], v[242:243]
    v_pk_fma_f32 v[246:247], v[222:223], v[34:35], v[246:247]
    v_add_f32 v227, v240, v241
    v_add_f32 v228, v242, v243
    v_add_f32 v229, v246, v247
    v_permlane32_swap_b32 v224, v227
    v_permlane32_swap_b32 v225, v228
    v_permlane32_swap_b32 v226, v229
    v_add_f32 v224, v224, v227
    v_add_f32 v225, v225, v228
    v_add_f32 v226, v226, v229
    v_add_f32_dpp v224, v224, v224 row_ror:8 row_mask:0xf bank_mask:0xf
    v_add_f32_dpp v225, v225, v225 row_ror:8 row_mask:0xf bank_mask:0xf
    v_add_f32_dpp v226, v226, v226 row_ror:8 row_mask:0xf bank_mask:0xf
    v_add_f32_dpp v224, v224, v224 row_ror:4 row_mask:0xf bank_mask:0xf
    v_add_f32_dpp v225, v225, v225 row_ror:4 row_mask:0xf bank_mask:0xf
    v_add_f32_dpp v226, v226, v226 row_ror:4 row_mask:0xf bank_mask:0xf
    v_add_f32_dpp v224, v224, v224 row_ror:2 row_mask:0xf bank_mask:0xf
    v_add_f32_dpp v225, v225, v225 row_ror:2 row_mask:0xf bank_mask:0xf
    v_add_f32_dpp v226, v226, v226 row_ror:2 row_mask:0xf bank_mask:0xf
    v_add_f32_dpp v224, v224, v224 row_ror:1 row_mask:0xf bank_mask:0xf
    v_add_f32_dpp v225, v225, v225 row_ror:1 row_mask:0xf bank_mask:0xf
    v_add_f32_dpp v226, v226, v226 row_ror:1 row_mask:0xf bank_mask:0xf
    v_mov_b32 v227, v224
    v_mov_b32 v228, v225
    v_mov_b32 v229, v226
    v_permlane16_swap_b32 v224, v227
    v_permlane16_swap_b32 v225, v228
    v_permlane16_swap_b32 v226, v229
    v_add_f32 v224, v224, v227
    v_add_f32 v225, v225, v228
    v_add_f32 v226, v226, v229
    v_mul_f32 v248, 0x3b000000, v224
    v_mul_f32 v225, 0x3b000000, v225
    v_fma_f32 v249, -v248, v248, v225
    v_add_f32 v225, 0x3727c5ac, v249
    v_rsq_f32 v250, v225
    v_fma_f32 v226, -v248, s34, v226
    v_mul_f32 v251, -v248, v250
    v_mul_f32 v252, v250, v226
    v_ashrrev_i32 v230, 31, v252
    v_or_b32 v230, 0x80000000, v230
    v_xor_b32 v230, v252, v230
    v_and_b32 v230, 0xfffff800, v230
    v_or_b32 v230, v184, v230
    s_nop 0
    v_readlane_b32 s50, v230, 0
    v_readlane_b32 s51, v230, 32
    s_lshl_b32 s27, s21, 2
    v_mov_b32 v231, s27
    s_max_u32 s52, s50, s51
    v_mov_b32 v230, s52
    ds_write_b32 v231, v230 offset:27392
    v_mov_b32 v230, s36
    v_mov_b32 v231, s38
    v_cmp_gt_u32 vcc, 32, v1
    v_add_f32 v229, 1.0, v250
    s_nop 0
    v_cndmask_b32 v230, v231, v230, vcc
    v_add_f32 v230, v230, v251
    v_readlane_b32 s42, v229, 0
    v_readlane_b32 s44, v229, 32
    v_readlane_b32 s43, v230, 0
    v_readlane_b32 s45, v230, 32
    s_waitcnt lgkmcnt(0)
    s_barrier
    v_mov_b32 v236, 0
    ds_read_b128 v[232:235], v236 offset:27392
    v_pk_fma_f32 v[4:5], v[208:209], s[42:43], s[42:43] op_sel:[0,0,1] op_sel_hi:[1,0,1]
    v_pk_fma_f32 v[6:7], v[210:211], s[42:43], s[42:43] op_sel:[0,0,1] op_sel_hi:[1,0,1]
    v_pk_fma_f32 v[8:9], v[212:213], s[42:43], s[42:43] op_sel:[0,0,1] op_sel_hi:[1,0,1]
    v_pk_fma_f32 v[10:11], v[214:215], s[42:43], s[42:43] op_sel:[0,0,1] op_sel_hi:[1,0,1]
    v_pk_fma_f32 v[12:13], v[216:217], s[44:45], s[44:45] op_sel:[0,0,1] op_sel_hi:[1,0,1]
    v_pk_fma_f32 v[14:15], v[218:219], s[44:45], s[44:45] op_sel:[0,0,1] op_sel_hi:[1,0,1]
    v_pk_fma_f32 v[16:17], v[220:221], s[44:45], s[44:45] op_sel:[0,0,1] op_sel_hi:[1,0,1]
    v_pk_fma_f32 v[18:19], v[222:223], s[44:45], s[44:45] op_sel:[0,0,1] op_sel_hi:[1,0,1]
    s_waitcnt lgkmcnt(0)
    v_max3_u32 v232, v232, v233, v234
    v_max_u32 v232, v232, v235
    s_nop 0
    v_readfirstlane_b32 s27, v232
    s_nop 0
    s_cmp_eq_u32 s27, s52
    s_cselect_b32 s69, 1, 0
    s_cbranch_scc0 L_nohdr_67
    s_lshl_b32 s27, s20, 12
    s_add_u32 s25, s27, 7340032
    v_mov_b32 v233, s52
    s_mov_b64 exec, 1
    buffer_store_dword v233, v236, s[4:7], s25 offen sc1
    s_mov_b64 exec, -1
L_nohdr_67:
    s_cmp_eq_u32 s69, 0
    s_cbranch_scc1 L_nopub_68
    s_lshl_b32 s27, s20, 12
    s_add_u32 s25, s27, 7340032
    s_cmp_gt_u32 s51, s50
    s_cbranch_scc1 L_pubv_69
    v_rcp_f32 v208, s42
    v_mov_b32 v209, s43
    v_mov_b32 v210, s42
    v_add_f32 v210, -1.0, v210
    v_subrev_f32 v211, s36, v209
    v_mul_f32 v212, v210, v208
    v_fma_f32 v214, -v212, v209, v211
    v_pk_fma_f32 v[216:217], v[4:5], v[212:213], v[214:215] op_sel_hi:[1,0,0]
    v_pk_fma_f32 v[218:219], v[6:7], v[212:213], v[214:215] op_sel_hi:[1,0,0]
    v_pk_fma_f32 v[220:221], v[8:9], v[212:213], v[214:215] op_sel_hi:[1,0,0]
    v_pk_fma_f32 v[222:223], v[10:11], v[212:213], v[214:215] op_sel_hi:[1,0,0]
    v_cvt_pk_bf16_f32 v224, v216, v217
    v_cvt_pk_bf16_f32 v225, v218, v219
    v_cvt_pk_bf16_f32 v226, v220, v221
    v_cvt_pk_bf16_f32 v227, v222, v223
    v_lshlrev_b32 v209, 4, v1
    v_lshlrev_b32 v210, 5, v1
    buffer_store_dwordx4 v[224:227], v209, s[4:7], s25 offen offset:128 sc1
    buffer_store_dwordx4 v[4:7], v210, s[4:7], s25 offen offset:1152 sc1
    buffer_store_dwordx4 v[8:11], v210, s[4:7], s25 offen offset:1168 sc1
    s_branch L_pubj_70
L_pubv_69:
    v_rcp_f32 v208, s44
    v_mov_b32 v209, s45
    v_mov_b32 v210, s44
    v_add_f32 v210, -1.0, v210
    v_subrev_f32 v211, s38, v209
    v_mul_f32 v212, v210, v208
    v_fma_f32 v214, -v212, v209, v211
    v_pk_fma_f32 v[216:217], v[12:13], v[212:213], v[214:215] op_sel_hi:[1,0,0]
    v_pk_fma_f32 v[218:219], v[14:15], v[212:213], v[214:215] op_sel_hi:[1,0,0]
    v_pk_fma_f32 v[220:221], v[16:17], v[212:213], v[214:215] op_sel_hi:[1,0,0]
    v_pk_fma_f32 v[222:223], v[18:19], v[212:213], v[214:215] op_sel_hi:[1,0,0]
    v_mov_b32_dpp v228, v216 wave_rol:1 row_mask:0xf bank_mask:0xf
    v_mov_b32_dpp v232, v12 wave_rol:1 row_mask:0xf bank_mask:0xf
    v_cvt_pk_bf16_f32 v225, v222, v221
    v_cvt_pk_bf16_f32 v226, v220, v219
    v_cvt_pk_bf16_f32 v227, v218, v217
    v_cvt_pk_bf16_f32 v224, v228, v223
    v_mov_b32 v233, v19
    v_mov_b32 v234, v18
    v_mov_b32 v235, v17
    v_mov_b32 v236, v16
    v_mov_b32 v237, v15
    v_mov_b32 v238, v14
    v_mov_b32 v239, v13
    v_lshlrev_b32 v209, 4, v1
    v_sub_u32 v209, 1008, v209
    v_lshlrev_b32 v210, 1, v209
    buffer_store_dwordx4 v[224:227], v209, s[4:7], s25 offen offset:128 sc1
    buffer_store_dwordx4 v[232:235], v210, s[4:7], s25 offen offset:1152 sc1
    buffer_store_dwordx4 v[236:239], v210, s[4:7], s25 offen offset:1168 sc1
L_pubj_70:
L_nopub_68:
    s_waitcnt vmcnt(0)
    s_barrier
    s_mov_b32 s25, 7340032
    buffer_load_dword v208, v180, s[4:7], s25 offen  sc1
    s_waitcnt vmcnt(0)
    s_mov_b32 s25, 7340032
    v_cmp_eq_u32 vcc, -1, v208
    s_cbranch_vccnz L_poll_71
L_ok_72:
    v_max_u32_dpp v208, v208, v208 row_ror:8 row_mask:0xf bank_mask:0xf
    s_nop 1
    v_max_u32_dpp v208, v208, v208 row_ror:4 row_mask:0xf bank_mask:0xf
    s_nop 1
    v_max_u32_dpp v208, v208, v208 row_ror:2 row_mask:0xf bank_mask:0xf
    s_nop 1
    v_max_u32_dpp v208, v208, v208 row_ror:1 row_mask:0xf bank_mask:0xf
    v_mov_b32 v209, v208
    s_nop 1
    v_permlane16_swap_b32 v208, v209
    v_max_u32 v208, v208, v209
    v_mov_b32 v209, v208
    s_nop 1
    v_permlane32_swap_b32 v208, v209
    v_max_u32 v208, v208, v209
    s_lshl_b32 s27, s21, 2
    v_mov_b32 v209, s27
    ds_write_b32 v209, v208 offset:27424
    v_mov_b32 v209, 0
    s_waitcnt lgkmcnt(0)
    s_barrier
    ds_read_b128 v[212:215], v209 offset:27424
    s_waitcnt lgkmcnt(0)
    v_max3_u32 v212, v212, v213, v214
    v_max_u32 v212, v212, v215
    s_nop 0
    v_readfirstlane_b32 s52, v212
    s_nop 0
    s_and_b32 s31, s52, 2047
    s_lshr_b32 s27, s31, 2
    s_sub_u32 s28, 511, s27
    s_sub_u32 s29, 512, s27
    s_and_b32 s29, s29, 255
    s_and_b32 s32, s31, 3
    s_cmp_eq_u32 s32, 0
    s_cselect_b32 s28, s29, s28
    s_cmp_lt_u32 s31, 1024
    s_cselect_b32 s28, s27, s28
    s_lshl_b32 s32, s28, 12
    s_add_u32 s32, s32, 7340032
    s_cmp_ge_u32 s68, 172
    s_cbranch_scc1 L_nox_73
    s_lshl_b32 s27, s21, 8
    v_lshlrev_b32 v228, 4, v3
    v_add_u32 v228, s27, v228
    buffer_load_dwordx4 v[208:211], v228, s[4:7], s32 offen offset:128 sc1
    buffer_load_dwordx4 v[212:215], v228, s[4:7], s32 offen offset:192 sc1
    buffer_load_dwordx4 v[216:219], v228, s[4:7], s32 offen offset:256 sc1
    buffer_load_dwordx4 v[220:223], v228, s[4:7], s32 offen offset:320 sc1
L_nox_73:
    s_and_b32 s27, s52, 0xfffff800
    s_or_b32 s27, s27, 0x400
    s_ashr_i32 s28, s27, 31
    s_not_b32 s28, s28
    s_or_b32 s28, s28, 0x80000000
    s_xor_b32 s27, s27, s28
    v_mov_b32 v185, 0xbfb8aa3b
    v_mul_f32 v185, s27, v185
    v_exp_f32 v185, v185
    s_nop 0
    v_add_f32 v185, 1.0, v185
    v_rcp_f32 v185, v185
    s_cmp_eq_u32 s31, s22
    s_cbranch_scc1 L_noout_74
    v_cvt_pk_bf16_f32 v232, v4, v5
    v_cvt_pk_bf16_f32 v233, v6, v7
    v_cvt_pk_bf16_f32 v234, v8, v9
    v_cvt_pk_bf16_f32 v235, v10, v11
    buffer_store_dwordx4 v[232:235], v176, s[12:15], 0 offen sc1
L_noout_74:
    s_cmp_eq_u32 s31, s23
    s_cbranch_scc1 L_noout_75
    v_mov_b32_dpp v240, v12 wave_rol:1 row_mask:0xf bank_mask:0xf
    v_cvt_pk_bf16_f32 v237, v18, v17
    v_cvt_pk_bf16_f32 v238, v16, v15
    v_cvt_pk_bf16_f32 v239, v14, v13
    v_cvt_pk_bf16_f32 v236, v240, v19
    buffer_store_dwordx4 v[236:239], v177, s[12:15], 0 offen sc1
L_noout_75:
    s_waitcnt vmcnt(0)
    s_cmp_ge_u32 s68, 172
    s_cbranch_scc1 L_noffn_76
    v_max3_u32 v186, v208, v209, v210
    v_max3_u32 v186, v186, v211, v212
    v_max3_u32 v186, v186, v213, v214
    v_max3_u32 v186, v186, v215, v216
    v_max3_u32 v186, v186, v217, v218
    v_max3_u32 v186, v186, v219, v220
    v_max3_u32 v186, v186, v221, v222
    v_max_u32 v186, v186, v223
    v_cmp_eq_u32 vcc, -1, v186
    s_cbranch_vccnz L_poll_77
L_ok_78:
    v_mfma_f32_16x16x32_bf16 v[224:227], v[128:131], v[208:211], 0
    v_mfma_f32_16x16x32_bf16 v[224:227], v[132:135], v[212:215], v[224:227]
    v_mfma_f32_16x16x32_bf16 v[224:227], v[136:139], v[216:219], v[224:227]
    v_mfma_f32_16x16x32_bf16 v[224:227], v[140:143], v[220:223], v[224:227]
    v_lshlrev_b32 v229, 6, v3
    s_lshl_b32 s27, s21, 2
    v_add_u32 v229, s27, v229
    v_and_b32 v230, 31, v1
    v_lshlrev_b32 v230, 2, v230
    s_mov_b32 exec_lo, 0x00010001
    s_mov_b32 exec_hi, 0x00010001
    s_nop 0
    ds_write_b32 v229, v224 offset:27136
    ds_write_b32 v229, v225 offset:27152
    ds_write_b32 v229, v226 offset:27168
    ds_write_b32 v229, v227 offset:27184
    s_mov_b64 exec, -1
    s_waitcnt lgkmcnt(0)
    s_barrier
    ds_read_b32 v220, v230 offset:27136
    ds_read_b32 v221, v230 offset:27264
    s_waitcnt lgkmcnt(0)
    v_add_f32_dpp v220, v220, v220 quad_perm:[1,0,3,2] row_mask:0xf bank_mask:0xf
    v_add_f32_dpp v221, v221, v221 quad_perm:[1,0,3,2] row_mask:0xf bank_mask:0xf
    s_nop 0
    v_add_f32_dpp v220, v220, v220 quad_perm:[2,3,0,1] row_mask:0xf bank_mask:0xf
    v_add_f32_dpp v221, v221, v221 quad_perm:[2,3,0,1] row_mask:0xf bank_mask:0xf
    v_mul_f32 v222, 0xbfb8aa3b, v220
    v_exp_f32 v222, v222
    v_mul_f32 v221, v221, v185
    v_add_f32 v222, 1.0, v222
    v_rcp_f32 v222, v222
    v_mul_f32 v220, v220, v221
    v_mul_f32 v220, v220, v222
    s_nop 0
    v_readlane_b32 s54, v220, 0
    v_readlane_b32 s55, v220, 4
    v_readlane_b32 s56, v220, 8
    v_readlane_b32 s57, v220, 12
    v_readlane_b32 s58, v220, 16
    v_readlane_b32 s59, v220, 20
    v_readlane_b32 s60, v220, 24
    v_readlane_b32 s61, v220, 28
    v_pk_mul_f32 v[224:225], v[144:145], s[54:55] op_sel_hi:[1,0]
    v_pk_fma_f32 v[224:225], v[146:147], s[54:55], v[224:225] op_sel:[0,1,0] op_sel_hi:[1,1,1]
    v_pk_fma_f32 v[224:225], v[148:149], s[56:57], v[224:225] op_sel_hi:[1,0,1]
    v_pk_fma_f32 v[224:225], v[150:151], s[56:57], v[224:225] op_sel:[0,1,0] op_sel_hi:[1,1,1]
    v_pk_fma_f32 v[224:225], v[152:153], s[58:59], v[224:225] op_sel_hi:[1,0,1]
    v_pk_fma_f32 v[224:225], v[154:155], s[58:59], v[224:225] op_sel:[0,1,0] op_sel_hi:[1,1,1]
    v_pk_fma_f32 v[224:225], v[156:157], s[60:61], v[224:225] op_sel_hi:[1,0,1]
    v_pk_fma_f32 v[224:225], v[158:159], s[60:61], v[224:225] op_sel:[0,1,0] op_sel_hi:[1,1,1]
    s_mov_b32 s25, 8912896
    buffer_store_dwordx2 v[224:225], v181, s[4:7], s25 offen sc1
L_noffn_76:
    s_waitcnt vmcnt(0)
    s_sub_u32 s29, s20, 192
    s_bitcmp1_b32 s20, 0
    s_cselect_b32 s29, -1, s29
    s_lshr_b32 s29, s29, 1
    s_cmp_ge_u32 s29, 32
    s_cbranch_scc1 L_nored_79
    v_lshrrev_b32 v228, 4, v0
    v_and_b32 v230, 15, v0
    v_lshlrev_b32 v230, 2, v230
    s_lshl_b32 s27, s29, 6
    v_add_u32 v233, s27, v230
    v_lshl_add_u32 v229, v228, 11, v233
    v_add_u32 v231, 327680, v229
    v_mov_b32 v232, 0x7f000000
    v_cmp_gt_u32 vcc, 12, v228
    s_nop 1
    v_cndmask_b32 v231, v232, v231, vcc
    s_mov_b32 s25, 8912896
    buffer_load_dword v208, v229, s[4:7], s25 offen  sc1
    s_mov_b32 s25, 8945664
    buffer_load_dword v209, v229, s[4:7], s25 offen  sc1
    s_mov_b32 s25, 8978432
    buffer_load_dword v210, v229, s[4:7], s25 offen  sc1
    s_mov_b32 s25, 9011200
    buffer_load_dword v211, v229, s[4:7], s25 offen  sc1
    s_mov_b32 s25, 9043968
    buffer_load_dword v212, v229, s[4:7], s25 offen  sc1
    s_mov_b32 s25, 9076736
    buffer_load_dword v213, v229, s[4:7], s25 offen  sc1
    s_mov_b32 s25, 9109504
    buffer_load_dword v214, v229, s[4:7], s25 offen  sc1
    s_mov_b32 s25, 9142272
    buffer_load_dword v215, v229, s[4:7], s25 offen  sc1
    s_mov_b32 s25, 9175040
    buffer_load_dword v216, v229, s[4:7], s25 offen  sc1
    s_mov_b32 s25, 9207808
    buffer_load_dword v217, v229, s[4:7], s25 offen  sc1
    s_mov_b32 s25, 8912896
    buffer_load_dword v218, v231, s[4:7], s25 offen  sc1
    buffer_load_dword v220, v233, s[4:7], s32 offen offset:1152 sc1
    s_waitcnt vmcnt(0)
    v_max3_u32 v186, v208, v209, v210
    v_max3_u32 v186, v186, v211, v212
    v_max3_u32 v186, v186, v213, v214
    v_max3_u32 v186, v186, v215, v216
    v_max3_u32 v186, v186, v217, v218
    v_max_u32 v186, v186, v220
    v_cmp_eq_u32 vcc, -1, v186
    s_cbranch_vccnz L_poll_80
L_ok_81:
    v_add_f32 v208, v208, v218
    v_add_f32 v209, v209, v217
    v_add_f32 v210, v210, v216
    v_add_f32 v211, v211, v215
    v_add_f32 v212, v212, v214
    v_add_f32 v208, v208, v213
    v_add_f32 v209, v209, v212
    v_add_f32 v210, v210, v211
    v_add_f32 v208, v208, v210
    v_add_f32 v208, v208, v209
    v_mov_b32 v209, v208
    s_nop 1
    v_permlane16_swap_b32 v208, v209
    v_add_f32 v208, v208, v209
    v_mov_b32 v209, v208
    s_nop 1
    v_permlane32_swap_b32 v208, v209
    v_add_f32 v208, v208, v209
    s_lshl_b32 s27, s21, 2
    v_lshl_add_u32 v232, v230, 2, s27
    v_lshlrev_b32 v234, 2, v230
    s_mov_b64 exec, 0xffff
    ds_write_b32 v232, v208 offset:27456
    s_mov_b64 exec, -1
    s_waitcnt lgkmcnt(0)
    s_barrier
    s_cmp_lg_u32 s21, 0
    s_cbranch_scc1 L_nored_79
    ds_read_b128 v[236:239], v234 offset:27456
    s_waitcnt lgkmcnt(0)
    v_add_f32 v236, v236, v237
    v_add_f32 v238, v238, v239
    v_add_f32 v236, v236, v238
    v_add_f32 v236, v236, v220
    s_lshl_b32 s27, s31, 10
    v_lshrrev_b32 v233, 1, v233
    v_mov_b32_dpp v237, v236 quad_perm:[1,0,3,2] row_mask:0xf bank_mask:0xf
    v_add_u32 v233, s27, v233
    v_cvt_pk_bf16_f32 v236, v236, v237
    s_mov_b64 exec, 0x5555
    buffer_store_dword v236, v233, s[12:15], 0 offen sc1
    s_mov_b64 exec, -1
L_nored_79:
L_done:
    s_endpgm
L_loader:
    s_cmp_lt_u32 s33, 248
    s_cbranch_scc1 L_nohint_82
    s_mov_b32 s16, s72
    s_mov_b32 s17, s73
    s_mov_b32 s18, 2097152
    s_mov_b32 s19, 0x00020000
    s_mov_b32 s4, s96
    s_mov_b32 s5, s97
    s_mov_b32 s6, 10485760
    s_mov_b32 s7, 0x00020000
    s_lshl_b32 s28, s20, 12
    v_lshlrev_b32 v209, 4, v1
    v_add_u32 v210, s28, v209
    v_mov_b32 v212, 0
    buffer_load_dword v211, v210, s[16:19], 0 offen
    buffer_load_dword v212, v212, s[4:7], 0 offen
    s_and_b32 s27, s33, 7
    s_lshl_b32 s27, s27, 8
    v_mov_b32 v213, s27
    s_waitcnt vmcnt(0)
    s_mov_b32 s28, 0x9e3779b1
    v_mul_lo_u32 v212, v212, s28
    v_add_u32 v212, 0x7f4a7c15, v212
    s_mov_b64 exec, 1
    s_mov_b32 s25, 9449472
    buffer_store_dword v212, v213, s[4:7], s25 offen sc1
    s_mov_b64 exec, -1
L_nohint_82:
    s_mul_i32 s27, s33, 5632
    v_min_u32 v212, 43, v1
    v_lshlrev_b32 v212, 7, v212
    v_add_u32 v212, s27, v212
    s_mov_b32 s16, s86
    s_mov_b32 s17, s87
    s_mov_b32 s18, 1409024
    s_mov_b32 s19, 0x00020000
    buffer_load_dword v214, v212, s[16:19], 0 offen
    s_mov_b32 s16, s88
    s_mov_b32 s17, s89
    s_mov_b32 s18, 1409024
    s_mov_b32 s19, 0x00020000
    buffer_load_dword v214, v212, s[16:19], 0 offen
    s_cmp_ge_u32 s68, 172
    s_cbranch_scc1 L_end
    s_movk_i32 s29, 2752
    v_mul_lo_u32 v208, v1, s29
    s_lshl_b32 s28, s68, 4
    v_add_u32 v208, s28, v208
    v_lshlrev_b32 v209, 4, v1
    s_mov_b32 s16, s90
    s_mov_b32 s17, s91
    s_mov_b32 s18, 1409024
    s_mov_b32 s19, 0x00020000
    s_lshl_b32 s28, s68, 13
    s_mov_b32 m0, 44160
    s_add_u32 s25, s28, 0
    buffer_load_dwordx4 v209, s[16:19], s25 offen  lds
    s_mov_b32 m0, 45184
    s_add_u32 s25, s28, 1024
    buffer_load_dwordx4 v209, s[16:19], s25 offen  lds
    s_mov_b32 m0, 46208
    s_add_u32 s25, s28, 2048
    buffer_load_dwordx4 v209, s[16:19], s25 offen  lds
    s_mov_b32 m0, 47232
    s_add_u32 s25, s28, 3072
    buffer_load_dwordx4 v209, s[16:19], s25 offen  lds
    s_mov_b32 m0, 48256
    s_add_u32 s25, s28, 4096
    buffer_load_dwordx4 v209, s[16:19], s25 offen  lds
    s_mov_b32 m0, 49280
    s_add_u32 s25, s28, 5120
    buffer_load_dwordx4 v209, s[16:19], s25 offen  lds
    s_mov_b32 m0, 50304
    s_add_u32 s25, s28, 6144
    buffer_load_dwordx4 v209, s[16:19], s25 offen  lds
    s_mov_b32 m0, 51328
    s_add_u32 s25, s28, 7168
    buffer_load_dwordx4 v209, s[16:19], s25 offen  lds
    s_barrier
    s_mov_b32 s16, s86
    s_mov_b32 s17, s87
    s_mov_b32 s18, 1409024
    s_mov_b32 s19, 0x00020000
    s_add_u32 s27, s68, 0
    s_and_b32 s27, s27, 7
    s_lshl_b32 s28, s27, 10
    s_add_u32 m0, s28, 27776
    s_mul_i32 s25, s27, 176128
    buffer_load_dwordx4 v208, s[16:19], s25 offen  lds
    s_mov_b32 s16, s86
    s_mov_b32 s17, s87
    s_mov_b32 s18, 1409024
    s_mov_b32 s19, 0x00020000
    s_add_u32 s27, s68, 1
    s_and_b32 s27, s27, 7
    s_lshl_b32 s28, s27, 10
    s_add_u32 m0, s28, 27776
    s_mul_i32 s25, s27, 176128
    buffer_load_dwordx4 v208, s[16:19], s25 offen  lds
    s_mov_b32 s16, s86
    s_mov_b32 s17, s87
    s_mov_b32 s18, 1409024
    s_mov_b32 s19, 0x00020000
    s_add_u32 s27, s68, 2
    s_and_b32 s27, s27, 7
    s_lshl_b32 s28, s27, 10
    s_add_u32 m0, s28, 27776
    s_mul_i32 s25, s27, 176128
    buffer_load_dwordx4 v208, s[16:19], s25 offen  lds
    s_barrier
    s_mov_b32 s16, s86
    s_mov_b32 s17, s87
    s_mov_b32 s18, 1409024
    s_mov_b32 s19, 0x00020000
    s_add_u32 s27, s68, 3
    s_and_b32 s27, s27, 7
    s_lshl_b32 s28, s27, 10
    s_add_u32 m0, s28, 27776
    s_mul_i32 s25, s27, 176128
    buffer_load_dwordx4 v208, s[16:19], s25 offen  lds
    s_mov_b32 s16, s86
    s_mov_b32 s17, s87
    s_mov_b32 s18, 1409024
    s_mov_b32 s19, 0x00020000
    s_add_u32 s27, s68, 4
    s_and_b32 s27, s27, 7
    s_lshl_b32 s28, s27, 10
    s_add_u32 m0, s28, 27776
    s_mul_i32 s25, s27, 176128
    buffer_load_dwordx4 v208, s[16:19], s25 offen  lds
    s_mov_b32 s16, s86
    s_mov_b32 s17, s87
    s_mov_b32 s18, 1409024
    s_mov_b32 s19, 0x00020000
    s_add_u32 s27, s68, 5
    s_and_b32 s27, s27, 7
    s_lshl_b32 s28, s27, 10
    s_add_u32 m0, s28, 27776
    s_mul_i32 s25, s27, 176128
    buffer_load_dwordx4 v208, s[16:19], s25 offen  lds
    s_barrier
    s_mov_b32 s16, s86
    s_mov_b32 s17, s87
    s_mov_b32 s18, 1409024
    s_mov_b32 s19, 0x00020000
    s_add_u32 s27, s68, 6
    s_and_b32 s27, s27, 7
    s_lshl_b32 s28, s27, 10
    s_add_u32 m0, s28, 27776
    s_mul_i32 s25, s27, 176128
    buffer_load_dwordx4 v208, s[16:19], s25 offen  lds
    s_mov_b32 s16, s86
    s_mov_b32 s17, s87
    s_mov_b32 s18, 1409024
    s_mov_b32 s19, 0x00020000
    s_add_u32 s27, s68, 7
    s_and_b32 s27, s27, 7
    s_lshl_b32 s28, s27, 10
    s_add_u32 m0, s28, 27776
    s_mul_i32 s25, s27, 176128
    buffer_load_dwordx4 v208, s[16:19], s25 offen  lds
    s_barrier
    s_mov_b32 s16, s88
    s_mov_b32 s17, s89
    s_mov_b32 s18, 1409024
    s_mov_b32 s19, 0x00020000
    s_add_u32 s27, s68, 0
    s_and_b32 s27, s27, 7
    s_lshl_b32 s28, s27, 10
    s_add_u32 m0, s28, 35968
    s_mul_i32 s25, s27, 176128
    buffer_load_dwordx4 v208, s[16:19], s25 offen  lds
    s_mov_b32 s16, s88
    s_mov_b32 s17, s89
    s_mov_b32 s18, 1409024
    s_mov_b32 s19, 0x00020000
    s_add_u32 s27, s68, 1
    s_and_b32 s27, s27, 7
    s_lshl_b32 s28, s27, 10
    s_add_u32 m0, s28, 35968
    s_mul_i32 s25, s27, 176128
    buffer_load_dwordx4 v208, s[16:19], s25 offen  lds
    s_mov_b32 s16, s88
    s_mov_b32 s17, s89
    s_mov_b32 s18, 1409024
    s_mov_b32 s19, 0x00020000
    s_add_u32 s27, s68, 2
    s_and_b32 s27, s27, 7
    s_lshl_b32 s28, s27, 10
    s_add_u32 m0, s28, 35968
    s_mul_i32 s25, s27, 176128
    buffer_load_dwordx4 v208, s[16:19], s25 offen  lds
    s_mov_b32 s16, s88
    s_mov_b32 s17, s89
    s_mov_b32 s18, 1409024
    s_mov_b32 s19, 0x00020000
    s_add_u32 s27, s68, 3
    s_and_b32 s27, s27, 7
    s_lshl_b32 s28, s27, 10
    s_add_u32 m0, s28, 35968
    s_mul_i32 s25, s27, 176128
    buffer_load_dwordx4 v208, s[16:19], s25 offen  lds
    s_barrier
    s_mov_b32 s16, s88
    s_mov_b32 s17, s89
    s_mov_b32 s18, 1409024
    s_mov_b32 s19, 0x00020000
    s_add_u32 s27, s68, 4
    s_and_b32 s27, s27, 7
    s_lshl_b32 s28, s27, 10
    s_add_u32 m0, s28, 35968
    s_mul_i32 s25, s27, 176128
    buffer_load_dwordx4 v208, s[16:19], s25 offen  lds
    s_mov_b32 s16, s88
    s_mov_b32 s17, s89
    s_mov_b32 s18, 1409024
    s_mov_b32 s19, 0x00020000
    s_add_u32 s27, s68, 5
    s_and_b32 s27, s27, 7
    s_lshl_b32 s28, s27, 10
    s_add_u32 m0, s28, 35968
    s_mul_i32 s25, s27, 176128
    buffer_load_dwordx4 v208, s[16:19], s25 offen  lds
    s_barrier
    s_mov_b32 s16, s88
    s_mov_b32 s17, s89
    s_mov_b32 s18, 1409024
    s_mov_b32 s19, 0x00020000
    s_add_u32 s27, s68, 6
    s_and_b32 s27, s27, 7
    s_lshl_b32 s28, s27, 10
    s_add_u32 m0, s28, 35968
    s_mul_i32 s25, s27, 176128
    buffer_load_dwordx4 v208, s[16:19], s25 offen  lds
    s_mov_b32 s16, s88
    s_mov_b32 s17, s89
    s_mov_b32 s18, 1409024
    s_mov_b32 s19, 0x00020000
    s_add_u32 s27, s68, 7
    s_and_b32 s27, s27, 7
    s_lshl_b32 s28, s27, 10
    s_add_u32 m0, s28, 35968
    s_mul_i32 s25, s27, 176128
    buffer_load_dwordx4 v208, s[16:19], s25 offen  lds
    s_barrier
    s_waitcnt vmcnt(0)
    s_barrier
L_end:
    s_endpgm
L_ysp_17:
    v_fma_mix_f32 v4, v212, s30, v4 op_sel:[0,0,0] op_sel_hi:[1,0,0]
    v_fma_mix_f32 v5, v212, s30, v5 op_sel:[1,0,0] op_sel_hi:[1,0,0]
    v_fma_mix_f32 v6, v213, s30, v6 op_sel:[0,0,0] op_sel_hi:[1,0,0]
    v_fma_mix_f32 v7, v213, s30, v7 op_sel:[1,0,0] op_sel_hi:[1,0,0]
    v_fma_mix_f32 v8, v214, s30, v8 op_sel:[0,0,0] op_sel_hi:[1,0,0]
    v_fma_mix_f32 v9, v214, s30, v9 op_sel:[1,0,0] op_sel_hi:[1,0,0]
    v_fma_mix_f32 v10, v215, s30, v10 op_sel:[0,0,0] op_sel_hi:[1,0,0]
    v_fma_mix_f32 v11, v215, s30, v11 op_sel:[1,0,0] op_sel_hi:[1,0,0]
    v_fma_mix_f32 v12, v216, s30, v12 op_sel:[0,0,0] op_sel_hi:[1,0,0]
    v_fma_mix_f32 v13, v216, s30, v13 op_sel:[1,0,0] op_sel_hi:[1,0,0]
    v_fma_mix_f32 v14, v217, s30, v14 op_sel:[0,0,0] op_sel_hi:[1,0,0]
    v_fma_mix_f32 v15, v217, s30, v15 op_sel:[1,0,0] op_sel_hi:[1,0,0]
    v_fma_mix_f32 v16, v218, s30, v16 op_sel:[0,0,0] op_sel_hi:[1,0,0]
    v_fma_mix_f32 v17, v218, s30, v17 op_sel:[1,0,0] op_sel_hi:[1,0,0]
    v_fma_mix_f32 v18, v219, s30, v18 op_sel:[0,0,0] op_sel_hi:[1,0,0]
    v_fma_mix_f32 v19, v219, s30, v19 op_sel:[1,0,0] op_sel_hi:[1,0,0]
    s_branch L_yj_18
L_ysp_65:
    v_fma_mix_f32 v4, v200, s30, v4 op_sel:[0,0,0] op_sel_hi:[1,0,0]
    v_fma_mix_f32 v5, v200, s30, v5 op_sel:[1,0,0] op_sel_hi:[1,0,0]
    v_fma_mix_f32 v6, v201, s30, v6 op_sel:[0,0,0] op_sel_hi:[1,0,0]
    v_fma_mix_f32 v7, v201, s30, v7 op_sel:[1,0,0] op_sel_hi:[1,0,0]
    v_fma_mix_f32 v8, v202, s30, v8 op_sel:[0,0,0] op_sel_hi:[1,0,0]
    v_fma_mix_f32 v9, v202, s30, v9 op_sel:[1,0,0] op_sel_hi:[1,0,0]
    v_fma_mix_f32 v10, v203, s30, v10 op_sel:[0,0,0] op_sel_hi:[1,0,0]
    v_fma_mix_f32 v11, v203, s30, v11 op_sel:[1,0,0] op_sel_hi:[1,0,0]
    v_fma_mix_f32 v12, v204, s30, v12 op_sel:[0,0,0] op_sel_hi:[1,0,0]
    v_fma_mix_f32 v13, v204, s30, v13 op_sel:[1,0,0] op_sel_hi:[1,0,0]
    v_fma_mix_f32 v14, v205, s30, v14 op_sel:[0,0,0] op_sel_hi:[1,0,0]
    v_fma_mix_f32 v15, v205, s30, v15 op_sel:[1,0,0] op_sel_hi:[1,0,0]
    v_fma_mix_f32 v16, v206, s30, v16 op_sel:[0,0,0] op_sel_hi:[1,0,0]
    v_fma_mix_f32 v17, v206, s30, v17 op_sel:[1,0,0] op_sel_hi:[1,0,0]
    v_fma_mix_f32 v18, v207, s30, v18 op_sel:[0,0,0] op_sel_hi:[1,0,0]
    v_fma_mix_f32 v19, v207, s30, v19 op_sel:[1,0,0] op_sel_hi:[1,0,0]
    s_branch L_yj_66
L_poll_6:
    s_mov_b32 s26, 0
L_poll_6_r:
    s_sleep 2
    buffer_load_dwordx4 v[208:211], v216, s[4:7], s25 offen  sc1
    buffer_load_dwordx4 v[212:215], v216, s[4:7], s29 offen  sc1
    s_add_u32 s26, s26, 1
    s_cmp_gt_u32 s26, 40000
    s_cbranch_scc1 L_done
    s_waitcnt vmcnt(0)
    v_bitop3_b32 v186, v209, v211, s53 bitop3:0x7e
    v_bitop3_b32 v209, v213, v215, s53 bitop3:0x7e
    v_or_b32 v186, v186, v209
    v_cmp_ne_u32 vcc, 0, v186
    s_cbranch_vccnz L_poll_6_r
    s_branch L_ok_7
L_poll_10:
    s_mov_b32 s26, 0
L_poll_10_r:
    s_sleep 2
    buffer_load_dwordx4 v[208:211], v179, s[4:7], s25 offen  sc1
    s_add_u32 s26, s26, 1
    s_cmp_gt_u32 s26, 40000
    s_cbranch_scc1 L_done
    s_waitcnt vmcnt(0)
    v_max3_u32 v186, v208, v209, v210
    v_max_u32 v186, v186, v211
    v_cmp_eq_u32 vcc, -1, v186
    s_cbranch_vccnz L_poll_10_r
    s_branch L_ok_11
L_poll_15:
    s_mov_b32 s26, 0
L_poll_15_r:
    s_sleep 2
    buffer_load_dwordx4 v[220:223], v224, s[4:7], s29 offen  sc1
    s_add_u32 s26, s26, 1
    s_cmp_gt_u32 s26, 40000
    s_cbranch_scc1 L_done
    s_waitcnt vmcnt(0)
    v_max3_u32 v186, v220, v221, v222
    v_max_u32 v186, v186, v223
    v_cmp_eq_u32 vcc, -1, v186
    s_cbranch_vccnz L_poll_15_r
    s_branch L_ok_16
L_poll_25:
    s_mov_b32 s26, 0
L_poll_25_r:
    s_sleep 4
    buffer_load_dword v208, v180, s[4:7], s25 offen  sc1
    s_add_u32 s26, s26, 1
    s_cmp_gt_u32 s26, 40000
    s_cbranch_scc1 L_done
    s_waitcnt vmcnt(0)
    v_cmp_eq_u32 vcc, -1, v208
    s_cbranch_vccnz L_poll_25_r
    s_branch L_ok_26
L_poll_30:
    s_mov_b32 s26, 0
L_poll_30_r:
    s_sleep 2
    buffer_load_dwordx4 v[208:211], v228, s[4:7], s32 offen offset:128 sc1
    buffer_load_dwordx4 v[212:215], v228, s[4:7], s32 offen offset:192 sc1
    buffer_load_dwordx4 v[216:219], v228, s[4:7], s32 offen offset:256 sc1
    buffer_load_dwordx4 v[220:223], v228, s[4:7], s32 offen offset:320 sc1
    s_add_u32 s26, s26, 1
    s_cmp_gt_u32 s26, 40000
    s_cbranch_scc1 L_done
    s_waitcnt vmcnt(0)
    v_max3_u32 v186, v208, v209, v210
    v_max3_u32 v186, v186, v211, v212
    v_max3_u32 v186, v186, v213, v214
    v_max3_u32 v186, v186, v215, v216
    v_max3_u32 v186, v186, v217, v218
    v_max3_u32 v186, v186, v219, v220
    v_max3_u32 v186, v186, v221, v222
    v_max_u32 v186, v186, v223
    v_cmp_eq_u32 vcc, -1, v186
    s_cbranch_vccnz L_poll_30_r
    s_branch L_ok_31
L_poll_32:
    s_mov_b32 s26, 0
L_poll_32_r:
    s_sleep 2
    buffer_load_dwordx4 v[248:251], v179, s[4:7], s25 offen  sc1
    s_add_u32 s26, s26, 1
    s_cmp_gt_u32 s26, 40000
    s_cbranch_scc1 L_done
    s_waitcnt vmcnt(0)
    v_max3_u32 v186, v248, v249, v250
    v_max_u32 v186, v186, v251
    v_cmp_eq_u32 vcc, -1, v186
    s_cbranch_vccnz L_poll_32_r
    s_branch L_ok_33
L_poll_36:
    s_mov_b32 s26, 0
L_poll_36_r:
    s_sleep 2
    s_mov_b32 s25, 8388608
    buffer_load_dword v208, v229, s[4:7], s25 offen  sc1
    s_mov_b32 s25, 8421376
    buffer_load_dword v209, v229, s[4:7], s25 offen  sc1
    s_mov_b32 s25, 8454144
    buffer_load_dword v210, v229, s[4:7], s25 offen  sc1
    s_mov_b32 s25, 8486912
    buffer_load_dword v211, v229, s[4:7], s25 offen  sc1
    s_mov_b32 s25, 8519680
    buffer_load_dword v212, v229, s[4:7], s25 offen  sc1
    s_mov_b32 s25, 8552448
    buffer_load_dword v213, v229, s[4:7], s25 offen  sc1
    s_mov_b32 s25, 8585216
    buffer_load_dword v214, v229, s[4:7], s25 offen  sc1
    s_mov_b32 s25, 8617984
    buffer_load_dword v215, v229, s[4:7], s25 offen  sc1
    s_mov_b32 s25, 8650752
    buffer_load_dword v216, v229, s[4:7], s25 offen  sc1
    s_mov_b32 s25, 8683520
    buffer_load_dword v217, v229, s[4:7], s25 offen  sc1
    s_mov_b32 s25, 8388608
    buffer_load_dword v218, v231, s[4:7], s25 offen  sc1
    s_add_u32 s26, s26, 1
    s_cmp_gt_u32 s26, 40000
    s_cbranch_scc1 L_done
    s_waitcnt vmcnt(0)
    v_max3_u32 v186, v208, v209, v210
    v_max3_u32 v186, v186, v211, v212
    v_max3_u32 v186, v186, v213, v214
    v_max3_u32 v186, v186, v215, v216
    v_max3_u32 v186, v186, v217, v218
    v_cmp_eq_u32 vcc, -1, v186
    s_cbranch_vccnz L_poll_36_r
    s_branch L_ok_37
L_poll_39:
    s_mov_b32 s26, 0
L_poll_39_r:
    s_sleep 2
    buffer_load_dwordx4 v[192:195], v229, s[4:7], s32 offen offset:1152 sc1
    buffer_load_dwordx4 v[196:199], v229, s[4:7], s32 offen offset:1168 sc1
    s_add_u32 s26, s26, 1
    s_cmp_gt_u32 s26, 40000
    s_cbranch_scc1 L_done
    s_waitcnt vmcnt(0)
    v_max3_u32 v186, v192, v193, v194
    v_max3_u32 v186, v186, v195, v196
    v_max3_u32 v186, v186, v197, v198
    v_max_u32 v186, v186, v199
    v_cmp_eq_u32 vcc, -1, v186
    s_cbranch_vccnz L_poll_39_r
    s_branch L_ok_40
L_poll_42:
    s_mov_b32 s26, 0
L_poll_42_r:
    s_sleep 2
    buffer_load_dwordx4 v[208:211], v179, s[4:7], s25 offen  sc1
    s_add_u32 s26, s26, 1
    s_cmp_gt_u32 s26, 40000
    s_cbranch_scc1 L_done
    s_waitcnt vmcnt(0)
    v_max3_u32 v186, v208, v209, v210
    v_max_u32 v186, v186, v211
    v_cmp_eq_u32 vcc, -1, v186
    s_cbranch_vccnz L_poll_42_r
    s_branch L_ok_43
L_poll_47:
    s_mov_b32 s26, 0
L_poll_47_r:
    s_sleep 2
    buffer_load_dwordx4 v[220:223], v224, s[4:7], s29 offen  sc1
    s_add_u32 s26, s26, 1
    s_cmp_gt_u32 s26, 40000
    s_cbranch_scc1 L_done
    s_waitcnt vmcnt(0)
    v_max3_u32 v186, v220, v221, v222
    v_max_u32 v186, v186, v223
    v_cmp_eq_u32 vcc, -1, v186
    s_cbranch_vccnz L_poll_47_r
    s_branch L_ok_48
L_poll_54:
    s_mov_b32 s26, 0
L_poll_54_r:
    s_sleep 4
    buffer_load_dwordx4 v[224:227], v253, s[4:7], s25 offen  sc1
    buffer_load_dwordx4 v[228:231], v253, s[4:7], s25 offen offset:16 sc1
    s_add_u32 s26, s26, 1
    s_cmp_gt_u32 s26, 40000
    s_cbranch_scc1 L_done
    s_waitcnt vmcnt(0)
    v_max3_u32 v186, v224, v225, v226
    v_max3_u32 v186, v186, v227, v228
    v_max3_u32 v186, v186, v229, v230
    v_max_u32 v186, v186, v231
    v_cmp_eq_u32 vcc, -1, v186
    s_cbranch_vccnz L_poll_54_r
    s_branch L_ok_55
L_poll_56:
    s_mov_b32 s26, 0
L_poll_56_r:
    s_sleep 4
    buffer_load_dwordx4 v[224:227], v252, s[4:7], s25 offen  sc1
    buffer_load_dwordx4 v[228:231], v252, s[4:7], s25 offen offset:16 sc1
    s_add_u32 s26, s26, 1
    s_cmp_gt_u32 s26, 40000
    s_cbranch_scc1 L_done
    s_waitcnt vmcnt(0)
    v_max3_u32 v186, v224, v225, v226
    v_max3_u32 v186, v186, v227, v228
    v_max3_u32 v186, v186, v229, v230
    v_max_u32 v186, v186, v231
    v_cmp_eq_u32 vcc, -1, v186
    s_cbranch_vccnz L_poll_56_r
    s_branch L_ok_57
L_poll_60:
    s_mov_b32 s26, 0
L_poll_60_r:
    s_sleep 4
    buffer_load_dwordx4 v[224:227], v252, s[4:7], s25 offen  sc1
    buffer_load_dwordx4 v[228:231], v252, s[4:7], s25 offen offset:16 sc1
    s_add_u32 s26, s26, 1
    s_cmp_gt_u32 s26, 40000
    s_cbranch_scc1 L_done
    s_waitcnt vmcnt(0)
    v_max3_u32 v186, v224, v225, v226
    v_max3_u32 v186, v186, v227, v228
    v_max3_u32 v186, v186, v229, v230
    v_max_u32 v186, v186, v231
    v_cmp_eq_u32 vcc, -1, v186
    s_cbranch_vccnz L_poll_60_r
    s_branch L_ok_61
L_poll_71:
    s_mov_b32 s26, 0
L_poll_71_r:
    s_sleep 4
    buffer_load_dword v208, v180, s[4:7], s25 offen  sc1
    s_add_u32 s26, s26, 1
    s_cmp_gt_u32 s26, 40000
    s_cbranch_scc1 L_done
    s_waitcnt vmcnt(0)
    v_cmp_eq_u32 vcc, -1, v208
    s_cbranch_vccnz L_poll_71_r
    s_branch L_ok_72
L_poll_77:
    s_mov_b32 s26, 0
L_poll_77_r:
    s_sleep 2
    buffer_load_dwordx4 v[208:211], v228, s[4:7], s32 offen offset:128 sc1
    buffer_load_dwordx4 v[212:215], v228, s[4:7], s32 offen offset:192 sc1
    buffer_load_dwordx4 v[216:219], v228, s[4:7], s32 offen offset:256 sc1
    buffer_load_dwordx4 v[220:223], v228, s[4:7], s32 offen offset:320 sc1
    s_add_u32 s26, s26, 1
    s_cmp_gt_u32 s26, 40000
    s_cbranch_scc1 L_done
    s_waitcnt vmcnt(0)
    v_max3_u32 v186, v208, v209, v210
    v_max3_u32 v186, v186, v211, v212
    v_max3_u32 v186, v186, v213, v214
    v_max3_u32 v186, v186, v215, v216
    v_max3_u32 v186, v186, v217, v218
    v_max3_u32 v186, v186, v219, v220
    v_max3_u32 v186, v186, v221, v222
    v_max_u32 v186, v186, v223
    v_cmp_eq_u32 vcc, -1, v186
    s_cbranch_vccnz L_poll_77_r
    s_branch L_ok_78
L_poll_80:
    s_mov_b32 s26, 0
L_poll_80_r:
    s_sleep 2
    s_mov_b32 s25, 8912896
    buffer_load_dword v208, v229, s[4:7], s25 offen  sc1
    s_mov_b32 s25, 8945664
    buffer_load_dword v209, v229, s[4:7], s25 offen  sc1
    s_mov_b32 s25, 8978432
    buffer_load_dword v210, v229, s[4:7], s25 offen  sc1
    s_mov_b32 s25, 9011200
    buffer_load_dword v211, v229, s[4:7], s25 offen  sc1
    s_mov_b32 s25, 9043968
    buffer_load_dword v212, v229, s[4:7], s25 offen  sc1
    s_mov_b32 s25, 9076736
    buffer_load_dword v213, v229, s[4:7], s25 offen  sc1
    s_mov_b32 s25, 9109504
    buffer_load_dword v214, v229, s[4:7], s25 offen  sc1
    s_mov_b32 s25, 9142272
    buffer_load_dword v215, v229, s[4:7], s25 offen  sc1
    s_mov_b32 s25, 9175040
    buffer_load_dword v216, v229, s[4:7], s25 offen  sc1
    s_mov_b32 s25, 9207808
    buffer_load_dword v217, v229, s[4:7], s25 offen  sc1
    s_mov_b32 s25, 8912896
    buffer_load_dword v218, v231, s[4:7], s25 offen  sc1
    buffer_load_dword v220, v233, s[4:7], s32 offen offset:1152 sc1
    s_add_u32 s26, s26, 1
    s_cmp_gt_u32 s26, 40000
    s_cbranch_scc1 L_done
    s_waitcnt vmcnt(0)
    v_max3_u32 v186, v208, v209, v210
    v_max3_u32 v186, v186, v211, v212
    v_max3_u32 v186, v186, v213, v214
    v_max3_u32 v186, v186, v215, v216
    v_max3_u32 v186, v186, v217, v218
    v_max_u32 v186, v186, v220
    v_cmp_eq_u32 vcc, -1, v186
    s_cbranch_vccnz L_poll_80_r
    s_branch L_ok_81
L_code_end:
.p2align 8
L_tab:
.long 0x00004440,0x00004880,0x0000552e,0x00000200,0x00004480,0x0000552e,0x000054ee,0x00000002
.long 0x000044d0,0x000054ee,0x0000549e,0x00000004,0x00004510,0x0000549e,0x0000545e,0x00000006
.long 0x00004ce0,0x0000545e,0x00004c8e,0x00000008,0x00004d20,0x00004c8e,0x00004c4e,0x0000000a
.long 0x00004d70,0x00004c4e,0x00004bfe,0x0000000c,0x00004db0,0x00004bfe,0x00004bbe,0x0000000e
.long 0x00004442,0x00004bbe,0x0000552c,0x00000010,0x00004482,0x0000552c,0x000054ec,0x00000012
.long 0x000044d2,0x000054ec,0x0000549c,0x00000014,0x00004512,0x0000549c,0x0000545c,0x00000016
.long 0x00004ce2,0x0000545c,0x00004c8c,0x00000018,0x00004d22,0x00004c8c,0x00004c4c,0x0000001a
.long 0x00004d72,0x00004c4c,0x00004bfc,0x0000001c,0x00004db2,0x00004bfc,0x00004bbc,0x0000001e
.long 0x00004444,0x00004bbc,0x0000552a,0x00000020,0x00004484,0x0000552a,0x000054ea,0x00000022
.long 0x000044d4,0x000054ea,0x0000549a,0x00000024,0x00004514,0x0000549a,0x0000545a,0x00000026
.long 0x00004ce4,0x0000545a,0x00004c8a,0x00000028,0x00004d24,0x00004c8a,0x00004c4a,0x0000002a
.long 0x00004d74,0x00004c4a,0x00004bfa,0x0000002c,0x00004db4,0x00004bfa,0x00004bba,0x0000002e
.long 0x00004446,0x00004bba,0x00005528,0x00000030,0x00004486,0x00005528,0x000054e8,0x00000032
.long 0x000044d6,0x000054e8,0x00005498,0x00000034,0x00004516,0x00005498,0x00005458,0x00000036
.long 0x00004ce6,0x00005458,0x00004c88,0x00000038,0x00004d26,0x00004c88,0x00004c48,0x0000003a
.long 0x00004d76,0x00004c48,0x00004bf8,0x0000003c,0x00004db6,0x00004bf8,0x00004bb8,0x0000003e
.long 0x00004448,0x00004bb8,0x00005526,0x00000040,0x00004488,0x00005526,0x000054e6,0x00000042
.long 0x000044d8,0x000054e6,0x00005496,0x00000044,0x00004518,0x00005496,0x00005456,0x00000046
.long 0x00004ce8,0x00005456,0x00004c86,0x00000048,0x00004d28,0x00004c86,0x00004c46,0x0000004a
.long 0x00004d78,0x00004c46,0x00004bf6,0x0000004c,0x00004db8,0x00004bf6,0x00004bb6,0x0000004e
.long 0x0000444a,0x00004bb6,0x00005524,0x00000050,0x0000448a,0x00005524,0x000054e4,0x00000052
.long 0x000044da,0x000054e4,0x00005494,0x00000054,0x0000451a,0x00005494,0x00005454,0x00000056
.long 0x00004cea,0x00005454,0x00004c84,0x00000058,0x00004d2a,0x00004c84,0x00004c44,0x0000005a
.long 0x00004d7a,0x00004c44,0x00004bf4,0x0000005c,0x00004dba,0x00004bf4,0x00004bb4,0x0000005e
.long 0x0000444c,0x00004bb4,0x00005522,0x00000060,0x0000448c,0x00005522,0x000054e2,0x00000062
.long 0x000044dc,0x000054e2,0x00005492,0x00000064,0x0000451c,0x00005492,0x00005452,0x00000066
.long 0x00004cec,0x00005452,0x00004c82,0x00000068,0x00004d2c,0x00004c82,0x00004c42,0x0000006a
.long 0x00004d7c,0x00004c42,0x00004bf2,0x0000006c,0x00004dbc,0x00004bf2,0x00004bb2,0x0000006e
.long 0x0000444e,0x00004bb2,0x00005520,0x00000070,0x0000448e,0x00005520,0x000054e0,0x00000072
.long 0x000044de,0x000054e0,0x00005490,0x00000074,0x0000451e,0x00005490,0x00005450,0x00000076
.long 0x00004cee,0x00005450,0x00004c80,0x00000078,0x00004d2e,0x00004c80,0x00004c40,0x0000007a
.long 0x00004d7e,0x00004c40,0x00004bf0,0x0000007c,0x00004dbe,0x00004bf0,0x00004bb0,0x0000007e
.long 0x00004550,0x00004bb0,0x0000541e,0x00000080,0x00004590,0x0000541e,0x000053de,0x00000082
.long 0x000045e0,0x000053de,0x0000538e,0x00000084,0x00004620,0x0000538e,0x0000534e,0x00000086
.long 0x00004df0,0x0000534e,0x00004b7e,0x00000088,0x00004e30,0x00004b7e,0x00004b3e,0x0000008a
.long 0x00004e80,0x00004b3e,0x00004aee,0x0000008c,0x00004ec0,0x00004aee,0x00004aae,0x0000008e
.long 0x00004552,0x00004aae,0x0000541c,0x00000090,0x00004592,0x0000541c,0x000053dc,0x00000092
.long 0x000045e2,0x000053dc,0x0000538c,0x00000094,0x00004622,0x0000538c,0x0000534c,0x00000096
.long 0x00004df2,0x0000534c,0x00004b7c,0x00000098,0x00004e32,0x00004b7c,0x00004b3c,0x0000009a
.long 0x00004e82,0x00004b3c,0x00004aec,0x0000009c,0x00004ec2,0x00004aec,0x00004aac,0x0000009e
.long 0x00004554,0x00004aac,0x0000541a,0x000000a0,0x00004594,0x0000541a,0x000053da,0x000000a2
.long 0x000045e4,0x000053da,0x0000538a,0x000000a4,0x00004624,0x0000538a,0x0000534a,0x000000a6
.long 0x00004df4,0x0000534a,0x00004b7a,0x000000a8,0x00004e34,0x00004b7a,0x00004b3a,0x000000aa
.long 0x00004e84,0x00004b3a,0x00004aea,0x000000ac,0x00004ec4,0x00004aea,0x00004aaa,0x000000ae
.long 0x00004556,0x00004aaa,0x00005418,0x000000b0,0x00004596,0x00005418,0x000053d8,0x000000b2
.long 0x000045e6,0x000053d8,0x00005388,0x000000b4,0x00004626,0x00005388,0x00005348,0x000000b6
.long 0x00004df6,0x00005348,0x00004b78,0x000000b8,0x00004e36,0x00004b78,0x00004b38,0x000000ba
.long 0x00004e86,0x00004b38,0x00004ae8,0x000000bc,0x00004ec6,0x00004ae8,0x00004aa8,0x000000be
.long 0x00004558,0x00004aa8,0x00005416,0x000000c0,0x00004598,0x00005416,0x000053d6,0x000000c2
.long 0x000045e8,0x000053d6,0x00005386,0x000000c4,0x00004628,0x00005386,0x00005346,0x000000c6
.long 0x00004df8,0x00005346,0x00004b76,0x000000c8,0x00004e38,0x00004b76,0x00004b36,0x000000ca
.long 0x00004e88,0x00004b36,0x00004ae6,0x000000cc,0x00004ec8,0x00004ae6,0x00004aa6,0x000000ce
.long 0x0000455a,0x00004aa6,0x00005414,0x000000d0,0x0000459a,0x00005414,0x000053d4,0x000000d2
.long 0x000045ea,0x000053d4,0x00005384,0x000000d4,0x0000462a,0x00005384,0x00005344,0x000000d6
.long 0x00004dfa,0x00005344,0x00004b74,0x000000d8,0x00004e3a,0x00004b74,0x00004b34,0x000000da
.long 0x00004e8a,0x00004b34,0x00004ae4,0x000000dc,0x00004eca,0x00004ae4,0x00004aa4,0x000000de
.long 0x0000455c,0x00004aa4,0x00005412,0x000000e0,0x0000459c,0x00005412,0x000053d2,0x000000e2
.long 0x000045ec,0x000053d2,0x00005382,0x000000e4,0x0000462c,0x00005382,0x00005342,0x000000e6
.long 0x00004dfc,0x00005342,0x00004b72,0x000000e8,0x00004e3c,0x00004b72,0x00004b32,0x000000ea
.long 0x00004e8c,0x00004b32,0x00004ae2,0x000000ec,0x00004ecc,0x00004ae2,0x00004aa2,0x000000ee
.long 0x0000455e,0x00004aa2,0x00005410,0x000000f0,0x0000459e,0x00005410,0x000053d0,0x000000f2
.long 0x000045ee,0x000053d0,0x00005380,0x000000f4,0x0000462e,0x00005380,0x00005340,0x000000f6
.long 0x00004dfe,0x00005340,0x00004b70,0x000000f8,0x00004e3e,0x00004b70,0x00004b30,0x000000fa
.long 0x00004e8e,0x00004b30,0x00004ae0,0x000000fc,0x00004ece,0x00004ae0,0x00004aa0,0x000000fe
.long 0x00004660,0x00004aa0,0x0000530e,0x00000100,0x000046a0,0x0000530e,0x000052ce,0x00000102
.long 0x000046f0,0x000052ce,0x0000527e,0x00000104,0x00004730,0x0000527e,0x0000523e,0x00000106
.long 0x00004f00,0x0000523e,0x00004a6e,0x00000108,0x00004f40,0x00004a6e,0x00004a2e,0x0000010a
.long 0x00004f90,0x00004a2e,0x000049de,0x0000010c,0x00004fd0,0x000049de,0x0000499e,0x0000010e
.long 0x00004662,0x0000499e,0x0000530c,0x00000110,0x000046a2,0x0000530c,0x000052cc,0x00000112
.long 0x000046f2,0x000052cc,0x0000527c,0x00000114,0x00004732,0x0000527c,0x0000523c,0x00000116
.long 0x00004f02,0x0000523c,0x00004a6c,0x00000118,0x00004f42,0x00004a6c,0x00004a2c,0x0000011a
.long 0x00004f92,0x00004a2c,0x000049dc,0x0000011c,0x00004fd2,0x000049dc,0x0000499c,0x0000011e
.long 0x00004664,0x0000499c,0x0000530a,0x00000120,0x000046a4,0x0000530a,0x000052ca,0x00000122
.long 0x000046f4,0x000052ca,0x0000527a,0x00000124,0x00004734,0x0000527a,0x0000523a,0x00000126
.long 0x00004f04,0x0000523a,0x00004a6a,0x00000128,0x00004f44,0x00004a6a,0x00004a2a,0x0000012a
.long 0x00004f94,0x00004a2a,0x000049da,0x0000012c,0x00004fd4,0x000049da,0x0000499a,0x0000012e
.long 0x00004666,0x0000499a,0x00005308,0x00000130,0x000046a6,0x00005308,0x000052c8,0x00000132
.long 0x000046f6,0x000052c8,0x00005278,0x00000134,0x00004736,0x00005278,0x00005238,0x00000136
.long 0x00004f06,0x00005238,0x00004a68,0x00000138,0x00004f46,0x00004a68,0x00004a28,0x0000013a
.long 0x00004f96,0x00004a28,0x000049d8,0x0000013c,0x00004fd6,0x000049d8,0x00004998,0x0000013e
.long 0x00004668,0x00004998,0x00005306,0x00000140,0x000046a8,0x00005306,0x000052c6,0x00000142
.long 0x000046f8,0x000052c6,0x00005276,0x00000144,0x00004738,0x00005276,0x00005236,0x00000146
.long 0x00004f08,0x00005236,0x00004a66,0x00000148,0x00004f48,0x00004a66,0x00004a26,0x0000014a
.long 0x00004f98,0x00004a26,0x000049d6,0x0000014c,0x00004fd8,0x000049d6,0x00004996,0x0000014e
.long 0x0000466a,0x00004996,0x00005304,0x00000150,0x000046aa,0x00005304,0x000052c4,0x00000152
.long 0x000046fa,0x000052c4,0x00005274,0x00000154,0x0000473a,0x00005274,0x00005234,0x00000156
.long 0x00004f0a,0x00005234,0x00004a64,0x00000158,0x00004f4a,0x00004a64,0x00004a24,0x0000015a
.long 0x00004f9a,0x00004a24,0x000049d4,0x0000015c,0x00004fda,0x000049d4,0x00004994,0x0000015e
.long 0x0000466c,0x00004994,0x00005302,0x00000160,0x000046ac,0x00005302,0x000052c2,0x00000162
.long 0x000046fc,0x000052c2,0x00005272,0x00000164,0x0000473c,0x00005272,0x00005232,0x00000166
.long 0x00004f0c,0x00005232,0x00004a62,0x00000168,0x00004f4c,0x00004a62,0x00004a22,0x0000016a
.long 0x00004f9c,0x00004a22,0x000049d2,0x0000016c,0x00004fdc,0x000049d2,0x00004992,0x0000016e
.long 0x0000466e,0x00004992,0x00005300,0x00000170,0x000046ae,0x00005300,0x000052c0,0x00000172
.long 0x000046fe,0x000052c0,0x00005270,0x00000174,0x0000473e,0x00005270,0x00005230,0x00000176
.long 0x00004f0e,0x00005230,0x00004a60,0x00000178,0x00004f4e,0x00004a60,0x00004a20,0x0000017a
.long 0x00004f9e,0x00004a20,0x000049d0,0x0000017c,0x00004fde,0x000049d0,0x00004990,0x0000017e
.long 0x00004770,0x00004990,0x000051fe,0x00000180,0x000047b0,0x000051fe,0x000051be,0x00000182
.long 0x00004800,0x000051be,0x0000516e,0x00000184,0x00004840,0x0000516e,0x0000512e,0x00000186
.long 0x00005010,0x0000512e,0x0000495e,0x00000188,0x00005050,0x0000495e,0x0000491e,0x0000018a
.long 0x000050a0,0x0000491e,0x000048ce,0x0000018c,0x000050e0,0x000048ce,0x0000488e,0x0000018e
.long 0x00004772,0x0000488e,0x000051fc,0x00000190,0x000047b2,0x000051fc,0x000051bc,0x00000192
.long 0x00004802,0x000051bc,0x0000516c,0x00000194,0x00004842,0x0000516c,0x0000512c,0x00000196
.long 0x00005012,0x0000512c,0x0000495c,0x00000198,0x00005052,0x0000495c,0x0000491c,0x0000019a
.long 0x000050a2,0x0000491c,0x000048cc,0x0000019c,0x000050e2,0x000048cc,0x0000488c,0x0000019e
.long 0x00004774,0x0000488c,0x000051fa,0x000001a0,0x000047b4,0x000051fa,0x000051ba,0x000001a2
.long 0x00004804,0x000051ba,0x0000516a,0x000001a4,0x00004844,0x0000516a,0x0000512a,0x000001a6
.long 0x00005014,0x0000512a,0x0000495a,0x000001a8,0x00005054,0x0000495a,0x0000491a,0x000001aa
.long 0x000050a4,0x0000491a,0x000048ca,0x000001ac,0x000050e4,0x000048ca,0x0000488a,0x000001ae
.long 0x00004776,0x0000488a,0x000051f8,0x000001b0,0x000047b6,0x000051f8,0x000051b8,0x000001b2
.long 0x00004806,0x000051b8,0x00005168,0x000001b4,0x00004846,0x00005168,0x00005128,0x000001b6
.long 0x00005016,0x00005128,0x00004958,0x000001b8,0x00005056,0x00004958,0x00004918,0x000001ba
.long 0x000050a6,0x00004918,0x000048c8,0x000001bc,0x000050e6,0x000048c8,0x00004888,0x000001be
.long 0x00004778,0x00004888,0x000051f6,0x000001c0,0x000047b8,0x000051f6,0x000051b6,0x000001c2
.long 0x00004808,0x000051b6,0x00005166,0x000001c4,0x00004848,0x00005166,0x00005126,0x000001c6
.long 0x00005018,0x00005126,0x00004956,0x000001c8,0x00005058,0x00004956,0x00004916,0x000001ca
.long 0x000050a8,0x00004916,0x000048c6,0x000001cc,0x000050e8,0x000048c6,0x00004886,0x000001ce
.long 0x0000477a,0x00004886,0x000051f4,0x000001d0,0x000047ba,0x000051f4,0x000051b4,0x000001d2
.long 0x0000480a,0x000051b4,0x00005164,0x000001d4,0x0000484a,0x00005164,0x00005124,0x000001d6
.long 0x0000501a,0x00005124,0x00004954,0x000001d8,0x0000505a,0x00004954,0x00004914,0x000001da
.long 0x000050aa,0x00004914,0x000048c4,0x000001dc,0x000050ea,0x000048c4,0x00004884,0x000001de
.long 0x0000477c,0x00004884,0x000051f2,0x000001e0,0x000047bc,0x000051f2,0x000051b2,0x000001e2
.long 0x0000480c,0x000051b2,0x00005162,0x000001e4,0x0000484c,0x00005162,0x00005122,0x000001e6
.long 0x0000501c,0x00005122,0x00004952,0x000001e8,0x0000505c,0x00004952,0x00004912,0x000001ea
.long 0x000050ac,0x00004912,0x000048c2,0x000001ec,0x000050ec,0x000048c2,0x00004882,0x000001ee
.long 0x0000477e,0x00004882,0x000051f0,0x000001f0,0x000047be,0x000051f0,0x000051b0,0x000001f2
.long 0x0000480e,0x000051b0,0x00005160,0x000001f4,0x0000484e,0x00005160,0x00005120,0x000001f6
.long 0x0000501e,0x00005120,0x00004950,0x000001f8,0x0000505e,0x00004950,0x00004910,0x000001fa
.long 0x000050ae,0x00004910,0x000048c0,0x000001fc,0x000050ee,0x000048c0,0x00004880,0x000001fe
.long 0x000055c0,0x000062c8,0x000055c8,0x00000200,0x000055c2,0x000062ba,0x000065ba,0x000003fe
.long 0x000055c4,0x000062bc,0x000065bc,0x000003fc,0x000055c6,0x000062be,0x000065be,0x000003fa
.long 0x000055d0,0x000062b8,0x000065b8,0x000003f8,0x000055d2,0x000062aa,0x000065aa,0x000003f6
.long 0x000055d4,0x000062ac,0x000065ac,0x000003f4,0x000055d6,0x000062ae,0x000065ae,0x000003f2
.long 0x00005640,0x00006248,0x00006548,0x000003f0,0x000056b6,0x000061ce,0x000064ce,0x000003ee
.long 0x000056b4,0x000061cc,0x000064cc,0x000003ec,0x000056b2,0x000061ca,0x000064ca,0x000003ea
.long 0x000056b0,0x000061d8,0x000064d8,0x000003e8,0x000056a6,0x000061de,0x000064de,0x000003e6
.long 0x000056a4,0x000061dc,0x000064dc,0x000003e4,0x000056a2,0x000061da,0x000064da,0x000003e2
.long 0x000059c0,0x00005ec8,0x000061c8,0x000003e0,0x000059c2,0x00005eba,0x000061ba,0x000003de
.long 0x000059c4,0x00005ebc,0x000061bc,0x000003dc,0x000059c6,0x00005ebe,0x000061be,0x000003da
.long 0x000059d0,0x00005eb8,0x000061b8,0x000003d8,0x000059d2,0x00005eaa,0x000061aa,0x000003d6
.long 0x000059d4,0x00005eac,0x000061ac,0x000003d4,0x000059d6,0x00005eae,0x000061ae,0x000003d2
.long 0x00005a40,0x00005e48,0x00006148,0x000003d0,0x00005ab6,0x00005dce,0x000060ce,0x000003ce
.long 0x00005ab4,0x00005dcc,0x000060cc,0x000003cc,0x00005ab2,0x00005dca,0x000060ca,0x000003ca
.long 0x00005ab0,0x00005dd8,0x000060d8,0x000003c8,0x00005aa6,0x00005dde,0x000060de,0x000003c6
.long 0x00005aa4,0x00005ddc,0x000060dc,0x000003c4,0x00005aa2,0x00005dda,0x000060da,0x000003c2
.long 0x00005dc0,0x00005ac8,0x00005dc8,0x000003c0,0x00005dc2,0x00005aba,0x00005dba,0x000003be
.long 0x00005dc4,0x00005abc,0x00005dbc,0x000003bc,0x00005dc6,0x00005abe,0x00005dbe,0x000003ba
.long 0x00005dd0,0x00005ab8,0x00005db8,0x000003b8,0x00005dd2,0x00005aaa,0x00005daa,0x000003b6
.long 0x00005dd4,0x00005aac,0x00005dac,0x000003b4,0x00005dd6,0x00005aae,0x00005dae,0x000003b2
.long 0x00005e40,0x00005a48,0x00005d48,0x000003b0,0x00005eb6,0x000059ce,0x00005cce,0x000003ae
.long 0x00005eb4,0x000059cc,0x00005ccc,0x000003ac,0x00005eb2,0x000059ca,0x00005cca,0x000003aa
.long 0x00005eb0,0x000059d8,0x00005cd8,0x000003a8,0x00005ea6,0x000059de,0x00005cde,0x000003a6
.long 0x00005ea4,0x000059dc,0x00005cdc,0x000003a4,0x00005ea2,0x000059da,0x00005cda,0x000003a2
.long 0x000061c0,0x000056c8,0x000059c8,0x000003a0,0x000061c2,0x000056ba,0x000059ba,0x0000039e
.long 0x000061c4,0x000056bc,0x000059bc,0x0000039c,0x000061c6,0x000056be,0x000059be,0x0000039a
.long 0x000061d0,0x000056b8,0x000059b8,0x00000398,0x000061d2,0x000056aa,0x000059aa,0x00000396
.long 0x000061d4,0x000056ac,0x000059ac,0x00000394,0x000061d6,0x000056ae,0x000059ae,0x00000392
.long 0x00006240,0x00005648,0x00005948,0x00000390,0x000062b6,0x000055ce,0x000058ce,0x0000038e
.long 0x000062b4,0x000055cc,0x000058cc,0x0000038c,0x000062b2,0x000055ca,0x000058ca,0x0000038a
.long 0x000062b0,0x000055d8,0x000058d8,0x00000388,0x000062a6,0x000055de,0x000058de,0x00000386
.long 0x000062a4,0x000055dc,0x000058dc,0x00000384,0x000062a2,0x000055da,0x000058da,0x00000382
.long 0x000055e0,0x000062a8,0x000065a8,0x00000380,0x000055e2,0x0000629a,0x0000659a,0x0000037e
.long 0x000055e4,0x0000629c,0x0000659c,0x0000037c,0x000055e6,0x0000629e,0x0000659e,0x0000037a
.long 0x000055f0,0x00006298,0x00006598,0x00000378,0x000055f2,0x0000628a,0x0000658a,0x00000376
.long 0x000055f4,0x0000628c,0x0000658c,0x00000374,0x000055f6,0x0000628e,0x0000658e,0x00000372
.long 0x000056a0,0x000061e8,0x000064e8,0x00000370,0x00005696,0x000061ee,0x000064ee,0x0000036e
.long 0x00005694,0x000061ec,0x000064ec,0x0000036c,0x00005692,0x000061ea,0x000064ea,0x0000036a
.long 0x00005690,0x000061f8,0x000064f8,0x00000368,0x00005686,0x000061fe,0x000064fe,0x00000366
.long 0x00005684,0x000061fc,0x000064fc,0x00000364,0x00005682,0x000061fa,0x000064fa,0x00000362
.long 0x000059e0,0x00005ea8,0x000061a8,0x00000360,0x000059e2,0x00005e9a,0x0000619a,0x0000035e
.long 0x000059e4,0x00005e9c,0x0000619c,0x0000035c,0x000059e6,0x00005e9e,0x0000619e,0x0000035a
.long 0x000059f0,0x00005e98,0x00006198,0x00000358,0x000059f2,0x00005e8a,0x0000618a,0x00000356
.long 0x000059f4,0x00005e8c,0x0000618c,0x00000354,0x000059f6,0x00005e8e,0x0000618e,0x00000352
.long 0x00005aa0,0x00005de8,0x000060e8,0x00000350,0x00005a96,0x00005dee,0x000060ee,0x0000034e
.long 0x00005a94,0x00005dec,0x000060ec,0x0000034c,0x00005a92,0x00005dea,0x000060ea,0x0000034a
.long 0x00005a90,0x00005df8,0x000060f8,0x00000348,0x00005a86,0x00005dfe,0x000060fe,0x00000346
.long 0x00005a84,0x00005dfc,0x000060fc,0x00000344,0x00005a82,0x00005dfa,0x000060fa,0x00000342
.long 0x00005de0,0x00005aa8,0x00005da8,0x00000340,0x00005de2,0x00005a9a,0x00005d9a,0x0000033e
.long 0x00005de4,0x00005a9c,0x00005d9c,0x0000033c,0x00005de6,0x00005a9e,0x00005d9e,0x0000033a
.long 0x00005df0,0x00005a98,0x00005d98,0x00000338,0x00005df2,0x00005a8a,0x00005d8a,0x00000336
.long 0x00005df4,0x00005a8c,0x00005d8c,0x00000334,0x00005df6,0x00005a8e,0x00005d8e,0x00000332
.long 0x00005ea0,0x000059e8,0x00005ce8,0x00000330,0x00005e96,0x000059ee,0x00005cee,0x0000032e
.long 0x00005e94,0x000059ec,0x00005cec,0x0000032c,0x00005e92,0x000059ea,0x00005cea,0x0000032a
.long 0x00005e90,0x000059f8,0x00005cf8,0x00000328,0x00005e86,0x000059fe,0x00005cfe,0x00000326
.long 0x00005e84,0x000059fc,0x00005cfc,0x00000324,0x00005e82,0x000059fa,0x00005cfa,0x00000322
.long 0x000061e0,0x000056a8,0x000059a8,0x00000320,0x000061e2,0x0000569a,0x0000599a,0x0000031e
.long 0x000061e4,0x0000569c,0x0000599c,0x0000031c,0x000061e6,0x0000569e,0x0000599e,0x0000031a
.long 0x000061f0,0x00005698,0x00005998,0x00000318,0x000061f2,0x0000568a,0x0000598a,0x00000316
.long 0x000061f4,0x0000568c,0x0000598c,0x00000314,0x000061f6,0x0000568e,0x0000598e,0x00000312
.long 0x000062a0,0x000055e8,0x000058e8,0x00000310,0x00006296,0x000055ee,0x000058ee,0x0000030e
.long 0x00006294,0x000055ec,0x000058ec,0x0000030c,0x00006292,0x000055ea,0x000058ea,0x0000030a
.long 0x00006290,0x000055f8,0x000058f8,0x00000308,0x00006286,0x000055fe,0x000058fe,0x00000306
.long 0x00006284,0x000055fc,0x000058fc,0x00000304,0x00006282,0x000055fa,0x000058fa,0x00000302
.long 0x00005600,0x00006288,0x00006588,0x00000300,0x00005602,0x0000627a,0x0000657a,0x000002fe
.long 0x00005604,0x0000627c,0x0000657c,0x000002fc,0x00005606,0x0000627e,0x0000657e,0x000002fa
.long 0x00005610,0x00006278,0x00006578,0x000002f8,0x00005612,0x0000626a,0x0000656a,0x000002f6
.long 0x00005614,0x0000626c,0x0000656c,0x000002f4,0x00005616,0x0000626e,0x0000656e,0x000002f2
.long 0x00005680,0x00006208,0x00006508,0x000002f0,0x00005676,0x0000620e,0x0000650e,0x000002ee
.long 0x00005674,0x0000620c,0x0000650c,0x000002ec,0x00005672,0x0000620a,0x0000650a,0x000002ea
.long 0x00005670,0x00006218,0x00006518,0x000002e8,0x00005666,0x0000621e,0x0000651e,0x000002e6
.long 0x00005664,0x0000621c,0x0000651c,0x000002e4,0x00005662,0x0000621a,0x0000651a,0x000002e2
.long 0x00005a00,0x00005e88,0x00006188,0x000002e0,0x00005a02,0x00005e7a,0x0000617a,0x000002de
.long 0x00005a04,0x00005e7c,0x0000617c,0x000002dc,0x00005a06,0x00005e7e,0x0000617e,0x000002da
.long 0x00005a10,0x00005e78,0x00006178,0x000002d8,0x00005a12,0x00005e6a,0x0000616a,0x000002d6
.long 0x00005a14,0x00005e6c,0x0000616c,0x000002d4,0x00005a16,0x00005e6e,0x0000616e,0x000002d2
.long 0x00005a80,0x00005e08,0x00006108,0x000002d0,0x00005a76,0x00005e0e,0x0000610e,0x000002ce
.long 0x00005a74,0x00005e0c,0x0000610c,0x000002cc,0x00005a72,0x00005e0a,0x0000610a,0x000002ca
.long 0x00005a70,0x00005e18,0x00006118,0x000002c8,0x00005a66,0x00005e1e,0x0000611e,0x000002c6
.long 0x00005a64,0x00005e1c,0x0000611c,0x000002c4,0x00005a62,0x00005e1a,0x0000611a,0x000002c2
.long 0x00005e00,0x00005a88,0x00005d88,0x000002c0,0x00005e02,0x00005a7a,0x00005d7a,0x000002be
.long 0x00005e04,0x00005a7c,0x00005d7c,0x000002bc,0x00005e06,0x00005a7e,0x00005d7e,0x000002ba
.long 0x00005e10,0x00005a78,0x00005d78,0x000002b8,0x00005e12,0x00005a6a,0x00005d6a,0x000002b6
.long 0x00005e14,0x00005a6c,0x00005d6c,0x000002b4,0x00005e16,0x00005a6e,0x00005d6e,0x000002b2
.long 0x00005e80,0x00005a08,0x00005d08,0x000002b0,0x00005e76,0x00005a0e,0x00005d0e,0x000002ae
.long 0x00005e74,0x00005a0c,0x00005d0c,0x000002ac,0x00005e72,0x00005a0a,0x00005d0a,0x000002aa
.long 0x00005e70,0x00005a18,0x00005d18,0x000002a8,0x00005e66,0x00005a1e,0x00005d1e,0x000002a6
.long 0x00005e64,0x00005a1c,0x00005d1c,0x000002a4,0x00005e62,0x00005a1a,0x00005d1a,0x000002a2
.long 0x00006200,0x00005688,0x00005988,0x000002a0,0x00006202,0x0000567a,0x0000597a,0x0000029e
.long 0x00006204,0x0000567c,0x0000597c,0x0000029c,0x00006206,0x0000567e,0x0000597e,0x0000029a
.long 0x00006210,0x00005678,0x00005978,0x00000298,0x00006212,0x0000566a,0x0000596a,0x00000296
.long 0x00006214,0x0000566c,0x0000596c,0x00000294,0x00006216,0x0000566e,0x0000596e,0x00000292
.long 0x00006280,0x00005608,0x00005908,0x00000290,0x00006276,0x0000560e,0x0000590e,0x0000028e
.long 0x00006274,0x0000560c,0x0000590c,0x0000028c,0x00006272,0x0000560a,0x0000590a,0x0000028a
.long 0x00006270,0x00005618,0x00005918,0x00000288,0x00006266,0x0000561e,0x0000591e,0x00000286
.long 0x00006264,0x0000561c,0x0000591c,0x00000284,0x00006262,0x0000561a,0x0000591a,0x00000282
.long 0x00005620,0x00006268,0x00006568,0x00000280,0x00005622,0x0000625a,0x0000655a,0x0000027e
.long 0x00005624,0x0000625c,0x0000655c,0x0000027c,0x00005626,0x0000625e,0x0000655e,0x0000027a
.long 0x00005630,0x00006258,0x00006558,0x00000278,0x00005632,0x0000624a,0x0000654a,0x00000276
.long 0x00005634,0x0000624c,0x0000654c,0x00000274,0x00005636,0x0000624e,0x0000654e,0x00000272
.long 0x00005660,0x00006228,0x00006528,0x00000270,0x00005656,0x0000622e,0x0000652e,0x0000026e
.long 0x00005654,0x0000622c,0x0000652c,0x0000026c,0x00005652,0x0000622a,0x0000652a,0x0000026a
.long 0x00005650,0x00006238,0x00006538,0x00000268,0x00005646,0x0000623e,0x0000653e,0x00000266
.long 0x00005644,0x0000623c,0x0000653c,0x00000264,0x00005642,0x0000623a,0x0000653a,0x00000262
.long 0x00005a20,0x00005e68,0x00006168,0x00000260,0x00005a22,0x00005e5a,0x0000615a,0x0000025e
.long 0x00005a24,0x00005e5c,0x0000615c,0x0000025c,0x00005a26,0x00005e5e,0x0000615e,0x0000025a
.long 0x00005a30,0x00005e58,0x00006158,0x00000258,0x00005a32,0x00005e4a,0x0000614a,0x00000256
.long 0x00005a34,0x00005e4c,0x0000614c,0x00000254,0x00005a36,0x00005e4e,0x0000614e,0x00000252
.long 0x00005a60,0x00005e28,0x00006128,0x00000250,0x00005a56,0x00005e2e,0x0000612e,0x0000024e
.long 0x00005a54,0x00005e2c,0x0000612c,0x0000024c,0x00005a52,0x00005e2a,0x0000612a,0x0000024a
.long 0x00005a50,0x00005e38,0x00006138,0x00000248,0x00005a46,0x00005e3e,0x0000613e,0x00000246
.long 0x00005a44,0x00005e3c,0x0000613c,0x00000244,0x00005a42,0x00005e3a,0x0000613a,0x00000242
.long 0x00005e20,0x00005a68,0x00005d68,0x00000240,0x00005e22,0x00005a5a,0x00005d5a,0x0000023e
.long 0x00005e24,0x00005a5c,0x00005d5c,0x0000023c,0x00005e26,0x00005a5e,0x00005d5e,0x0000023a
.long 0x00005e30,0x00005a58,0x00005d58,0x00000238,0x00005e32,0x00005a4a,0x00005d4a,0x00000236
.long 0x00005e34,0x00005a4c,0x00005d4c,0x00000234,0x00005e36,0x00005a4e,0x00005d4e,0x00000232
.long 0x00005e60,0x00005a28,0x00005d28,0x00000230,0x00005e56,0x00005a2e,0x00005d2e,0x0000022e
.long 0x00005e54,0x00005a2c,0x00005d2c,0x0000022c,0x00005e52,0x00005a2a,0x00005d2a,0x0000022a
.long 0x00005e50,0x00005a38,0x00005d38,0x00000228,0x00005e46,0x00005a3e,0x00005d3e,0x00000226
.long 0x00005e44,0x00005a3c,0x00005d3c,0x00000224,0x00005e42,0x00005a3a,0x00005d3a,0x00000222
.long 0x00006220,0x00005668,0x00005968,0x00000220,0x00006222,0x0000565a,0x0000595a,0x0000021e
.long 0x00006224,0x0000565c,0x0000595c,0x0000021c,0x00006226,0x0000565e,0x0000595e,0x0000021a
.long 0x00006230,0x00005658,0x00005958,0x00000218,0x00006232,0x0000564a,0x0000594a,0x00000216
.long 0x00006234,0x0000564c,0x0000594c,0x00000214,0x00006236,0x0000564e,0x0000594e,0x00000212
.long 0x00006260,0x00005628,0x00005928,0x00000210,0x00006256,0x0000562e,0x0000592e,0x0000020e
.long 0x00006254,0x0000562c,0x0000592c,0x0000020c,0x00006252,0x0000562a,0x0000592a,0x0000020a
.long 0x00006250,0x00005638,0x00005938,0x00000208,0x00006246,0x0000563e,0x0000593e,0x00000206
.long 0x00006244,0x0000563c,0x0000593c,0x00000204,0x00006242,0x0000563a,0x0000593a,0x00000202
.long 0x00004440,0x00004440,0x00004660,0x00004660,0x00004880,0x0000552e,0x00004aa0,0x0000530e
.long 0x00004480,0x00004480,0x000046a0,0x000046a0,0x0000552e,0x000054ee,0x0000530e,0x000052ce
.long 0x000044d0,0x000044d0,0x000046f0,0x000046f0,0x000054ee,0x0000549e,0x000052ce,0x0000527e
.long 0x00004510,0x00004510,0x00004730,0x00004730,0x0000549e,0x0000545e,0x0000527e,0x0000523e
.long 0x00004ce0,0x00004ce0,0x00004f00,0x00004f00,0x0000545e,0x00004c8e,0x0000523e,0x00004a6e
.long 0x00004d20,0x00004d20,0x00004f40,0x00004f40,0x00004c8e,0x00004c4e,0x00004a6e,0x00004a2e
.long 0x00004d70,0x00004d70,0x00004f90,0x00004f90,0x00004c4e,0x00004bfe,0x00004a2e,0x000049de
.long 0x00004db0,0x00004db0,0x00004fd0,0x00004fd0,0x00004bfe,0x00004bbe,0x000049de,0x0000499e
.long 0x00004442,0x00004442,0x00004662,0x00004662,0x00004bbe,0x0000552c,0x0000499e,0x0000530c
.long 0x00004482,0x00004482,0x000046a2,0x000046a2,0x0000552c,0x000054ec,0x0000530c,0x000052cc
.long 0x000044d2,0x000044d2,0x000046f2,0x000046f2,0x000054ec,0x0000549c,0x000052cc,0x0000527c
.long 0x00004512,0x00004512,0x00004732,0x00004732,0x0000549c,0x0000545c,0x0000527c,0x0000523c
.long 0x00004ce2,0x00004ce2,0x00004f02,0x00004f02,0x0000545c,0x00004c8c,0x0000523c,0x00004a6c
.long 0x00004d22,0x00004d22,0x00004f42,0x00004f42,0x00004c8c,0x00004c4c,0x00004a6c,0x00004a2c
.long 0x00004d72,0x00004d72,0x00004f92,0x00004f92,0x00004c4c,0x00004bfc,0x00004a2c,0x000049dc
.long 0x00004db2,0x00004db2,0x00004fd2,0x00004fd2,0x00004bfc,0x00004bbc,0x000049dc,0x0000499c
.long 0x00004444,0x00004444,0x00004664,0x00004664,0x00004bbc,0x0000552a,0x0000499c,0x0000530a
.long 0x00004484,0x00004484,0x000046a4,0x000046a4,0x0000552a,0x000054ea,0x0000530a,0x000052ca
.long 0x000044d4,0x000044d4,0x000046f4,0x000046f4,0x000054ea,0x0000549a,0x000052ca,0x0000527a
.long 0x00004514,0x00004514,0x00004734,0x00004734,0x0000549a,0x0000545a,0x0000527a,0x0000523a
.long 0x00004ce4,0x00004ce4,0x00004f04,0x00004f04,0x0000545a,0x00004c8a,0x0000523a,0x00004a6a
.long 0x00004d24,0x00004d24,0x00004f44,0x00004f44,0x00004c8a,0x00004c4a,0x00004a6a,0x00004a2a
.long 0x00004d74,0x00004d74,0x00004f94,0x00004f94,0x00004c4a,0x00004bfa,0x00004a2a,0x000049da
.long 0x00004db4,0x00004db4,0x00004fd4,0x00004fd4,0x00004bfa,0x00004bba,0x000049da,0x0000499a
.long 0x00004446,0x00004446,0x00004666,0x00004666,0x00004bba,0x00005528,0x0000499a,0x00005308
.long 0x00004486,0x00004486,0x000046a6,0x000046a6,0x00005528,0x000054e8,0x00005308,0x000052c8
.long 0x000044d6,0x000044d6,0x000046f6,0x000046f6,0x000054e8,0x00005498,0x000052c8,0x00005278
.long 0x00004516,0x00004516,0x00004736,0x00004736,0x00005498,0x00005458,0x00005278,0x00005238
.long 0x00004ce6,0x00004ce6,0x00004f06,0x00004f06,0x00005458,0x00004c88,0x00005238,0x00004a68
.long 0x00004d26,0x00004d26,0x00004f46,0x00004f46,0x00004c88,0x00004c48,0x00004a68,0x00004a28
.long 0x00004d76,0x00004d76,0x00004f96,0x00004f96,0x00004c48,0x00004bf8,0x00004a28,0x000049d8
.long 0x00004db6,0x00004db6,0x00004fd6,0x00004fd6,0x00004bf8,0x00004bb8,0x000049d8,0x00004998
.long 0x00004448,0x00004448,0x00004668,0x00004668,0x00004bb8,0x00005526,0x00004998,0x00005306
.long 0x00004488,0x00004488,0x000046a8,0x000046a8,0x00005526,0x000054e6,0x00005306,0x000052c6
.long 0x000044d8,0x000044d8,0x000046f8,0x000046f8,0x000054e6,0x00005496,0x000052c6,0x00005276
.long 0x00004518,0x00004518,0x00004738,0x00004738,0x00005496,0x00005456,0x00005276,0x00005236
.long 0x00004ce8,0x00004ce8,0x00004f08,0x00004f08,0x00005456,0x00004c86,0x00005236,0x00004a66
.long 0x00004d28,0x00004d28,0x00004f48,0x00004f48,0x00004c86,0x00004c46,0x00004a66,0x00004a26
.long 0x00004d78,0x00004d78,0x00004f98,0x00004f98,0x00004c46,0x00004bf6,0x00004a26,0x000049d6
.long 0x00004db8,0x00004db8,0x00004fd8,0x00004fd8,0x00004bf6,0x00004bb6,0x000049d6,0x00004996
.long 0x0000444a,0x0000444a,0x0000466a,0x0000466a,0x00004bb6,0x00005524,0x00004996,0x00005304
.long 0x0000448a,0x0000448a,0x000046aa,0x000046aa,0x00005524,0x000054e4,0x00005304,0x000052c4
.long 0x000044da,0x000044da,0x000046fa,0x000046fa,0x000054e4,0x00005494,0x000052c4,0x00005274
.long 0x0000451a,0x0000451a,0x0000473a,0x0000473a,0x00005494,0x00005454,0x00005274,0x00005234
.long 0x00004cea,0x00004cea,0x00004f0a,0x00004f0a,0x00005454,0x00004c84,0x00005234,0x00004a64
.long 0x00004d2a,0x00004d2a,0x00004f4a,0x00004f4a,0x00004c84,0x00004c44,0x00004a64,0x00004a24
.long 0x00004d7a,0x00004d7a,0x00004f9a,0x00004f9a,0x00004c44,0x00004bf4,0x00004a24,0x000049d4
.long 0x00004dba,0x00004dba,0x00004fda,0x00004fda,0x00004bf4,0x00004bb4,0x000049d4,0x00004994
.long 0x0000444c,0x0000444c,0x0000466c,0x0000466c,0x00004bb4,0x00005522,0x00004994,0x00005302
.long 0x0000448c,0x0000448c,0x000046ac,0x000046ac,0x00005522,0x000054e2,0x00005302,0x000052c2
.long 0x000044dc,0x000044dc,0x000046fc,0x000046fc,0x000054e2,0x00005492,0x000052c2,0x00005272
.long 0x0000451c,0x0000451c,0x0000473c,0x0000473c,0x00005492,0x00005452,0x00005272,0x00005232
.long 0x00004cec,0x00004cec,0x00004f0c,0x00004f0c,0x00005452,0x00004c82,0x00005232,0x00004a62
.long 0x00004d2c,0x00004d2c,0x00004f4c,0x00004f4c,0x00004c82,0x00004c42,0x00004a62,0x00004a22
.long 0x00004d7c,0x00004d7c,0x00004f9c,0x00004f9c,0x00004c42,0x00004bf2,0x00004a22,0x000049d2
.long 0x00004dbc,0x00004dbc,0x00004fdc,0x00004fdc,0x00004bf2,0x00004bb2,0x000049d2,0x00004992
.long 0x0000444e,0x0000444e,0x0000466e,0x0000466e,0x00004bb2,0x00005520,0x00004992,0x00005300
.long 0x0000448e,0x0000448e,0x000046ae,0x000046ae,0x00005520,0x000054e0,0x00005300,0x000052c0
.long 0x000044de,0x000044de,0x000046fe,0x000046fe,0x000054e0,0x00005490,0x000052c0,0x00005270
.long 0x0000451e,0x0000451e,0x0000473e,0x0000473e,0x00005490,0x00005450,0x00005270,0x00005230
.long 0x00004cee,0x00004cee,0x00004f0e,0x00004f0e,0x00005450,0x00004c80,0x00005230,0x00004a60
.long 0x00004d2e,0x00004d2e,0x00004f4e,0x00004f4e,0x00004c80,0x00004c40,0x00004a60,0x00004a20
.long 0x00004d7e,0x00004d7e,0x00004f9e,0x00004f9e,0x00004c40,0x00004bf0,0x00004a20,0x000049d0
.long 0x00004dbe,0x00004dbe,0x00004fde,0x00004fde,0x00004bf0,0x00004bb0,0x000049d0,0x00004990
.long 0x00004550,0x00004550,0x00004770,0x00004770,0x00004bb0,0x0000541e,0x00004990,0x000051fe
.long 0x00004590,0x00004590,0x000047b0,0x000047b0,0x0000541e,0x000053de,0x000051fe,0x000051be
.long 0x000045e0,0x000045e0,0x00004800,0x00004800,0x000053de,0x0000538e,0x000051be,0x0000516e
.long 0x00004620,0x00004620,0x00004840,0x00004840,0x0000538e,0x0000534e,0x0000516e,0x0000512e
.long 0x00004df0,0x00004df0,0x00005010,0x00005010,0x0000534e,0x00004b7e,0x0000512e,0x0000495e
.long 0x00004e30,0x00004e30,0x00005050,0x00005050,0x00004b7e,0x00004b3e,0x0000495e,0x0000491e
.long 0x00004e80,0x00004e80,0x000050a0,0x000050a0,0x00004b3e,0x00004aee,0x0000491e,0x000048ce
.long 0x00004ec0,0x00004ec0,0x000050e0,0x000050e0,0x00004aee,0x00004aae,0x000048ce,0x0000488e
.long 0x00004552,0x00004552,0x00004772,0x00004772,0x00004aae,0x0000541c,0x0000488e,0x000051fc
.long 0x00004592,0x00004592,0x000047b2,0x000047b2,0x0000541c,0x000053dc,0x000051fc,0x000051bc
.long 0x000045e2,0x000045e2,0x00004802,0x00004802,0x000053dc,0x0000538c,0x000051bc,0x0000516c
.long 0x00004622,0x00004622,0x00004842,0x00004842,0x0000538c,0x0000534c,0x0000516c,0x0000512c
.long 0x00004df2,0x00004df2,0x00005012,0x00005012,0x0000534c,0x00004b7c,0x0000512c,0x0000495c
.long 0x00004e32,0x00004e32,0x00005052,0x00005052,0x00004b7c,0x00004b3c,0x0000495c,0x0000491c
.long 0x00004e82,0x00004e82,0x000050a2,0x000050a2,0x00004b3c,0x00004aec,0x0000491c,0x000048cc
.long 0x00004ec2,0x00004ec2,0x000050e2,0x000050e2,0x00004aec,0x00004aac,0x000048cc,0x0000488c
.long 0x00004554,0x00004554,0x00004774,0x00004774,0x00004aac,0x0000541a,0x0000488c,0x000051fa
.long 0x00004594,0x00004594,0x000047b4,0x000047b4,0x0000541a,0x000053da,0x000051fa,0x000051ba
.long 0x000045e4,0x000045e4,0x00004804,0x00004804,0x000053da,0x0000538a,0x000051ba,0x0000516a
.long 0x00004624,0x00004624,0x00004844,0x00004844,0x0000538a,0x0000534a,0x0000516a,0x0000512a
.long 0x00004df4,0x00004df4,0x00005014,0x00005014,0x0000534a,0x00004b7a,0x0000512a,0x0000495a
.long 0x00004e34,0x00004e34,0x00005054,0x00005054,0x00004b7a,0x00004b3a,0x0000495a,0x0000491a
.long 0x00004e84,0x00004e84,0x000050a4,0x000050a4,0x00004b3a,0x00004aea,0x0000491a,0x000048ca
.long 0x00004ec4,0x00004ec4,0x000050e4,0x000050e4,0x00004aea,0x00004aaa,0x000048ca,0x0000488a
.long 0x00004556,0x00004556,0x00004776,0x00004776,0x00004aaa,0x00005418,0x0000488a,0x000051f8
.long 0x00004596,0x00004596,0x000047b6,0x000047b6,0x00005418,0x000053d8,0x000051f8,0x000051b8
.long 0x000045e6,0x000045e6,0x00004806,0x00004806,0x000053d8,0x00005388,0x000051b8,0x00005168
.long 0x00004626,0x00004626,0x00004846,0x00004846,0x00005388,0x00005348,0x00005168,0x00005128
.long 0x00004df6,0x00004df6,0x00005016,0x00005016,0x00005348,0x00004b78,0x00005128,0x00004958
.long 0x00004e36,0x00004e36,0x00005056,0x00005056,0x00004b78,0x00004b38,0x00004958,0x00004918
.long 0x00004e86,0x00004e86,0x000050a6,0x000050a6,0x00004b38,0x00004ae8,0x00004918,0x000048c8
.long 0x00004ec6,0x00004ec6,0x000050e6,0x000050e6,0x00004ae8,0x00004aa8,0x000048c8,0x00004888
.long 0x00004558,0x00004558,0x00004778,0x00004778,0x00004aa8,0x00005416,0x00004888,0x000051f6
.long 0x00004598,0x00004598,0x000047b8,0x000047b8,0x00005416,0x000053d6,0x000051f6,0x000051b6
.long 0x000045e8,0x000045e8,0x00004808,0x00004808,0x000053d6,0x00005386,0x000051b6,0x00005166
.long 0x00004628,0x00004628,0x00004848,0x00004848,0x00005386,0x00005346,0x00005166,0x00005126
.long 0x00004df8,0x00004df8,0x00005018,0x00005018,0x00005346,0x00004b76,0x00005126,0x00004956
.long 0x00004e38,0x00004e38,0x00005058,0x00005058,0x00004b76,0x00004b36,0x00004956,0x00004916
.long 0x00004e88,0x00004e88,0x000050a8,0x000050a8,0x00004b36,0x00004ae6,0x00004916,0x000048c6
.long 0x00004ec8,0x00004ec8,0x000050e8,0x000050e8,0x00004ae6,0x00004aa6,0x000048c6,0x00004886
.long 0x0000455a,0x0000455a,0x0000477a,0x0000477a,0x00004aa6,0x00005414,0x00004886,0x000051f4
.long 0x0000459a,0x0000459a,0x000047ba,0x000047ba,0x00005414,0x000053d4,0x000051f4,0x000051b4
.long 0x000045ea,0x000045ea,0x0000480a,0x0000480a,0x000053d4,0x00005384,0x000051b4,0x00005164
.long 0x0000462a,0x0000462a,0x0000484a,0x0000484a,0x00005384,0x00005344,0x00005164,0x00005124
.long 0x00004dfa,0x00004dfa,0x0000501a,0x0000501a,0x00005344,0x00004b74,0x00005124,0x00004954
.long 0x00004e3a,0x00004e3a,0x0000505a,0x0000505a,0x00004b74,0x00004b34,0x00004954,0x00004914
.long 0x00004e8a,0x00004e8a,0x000050aa,0x000050aa,0x00004b34,0x00004ae4,0x00004914,0x000048c4
.long 0x00004eca,0x00004eca,0x000050ea,0x000050ea,0x00004ae4,0x00004aa4,0x000048c4,0x00004884
.long 0x0000455c,0x0000455c,0x0000477c,0x0000477c,0x00004aa4,0x00005412,0x00004884,0x000051f2
.long 0x0000459c,0x0000459c,0x000047bc,0x000047bc,0x00005412,0x000053d2,0x000051f2,0x000051b2
.long 0x000045ec,0x000045ec,0x0000480c,0x0000480c,0x000053d2,0x00005382,0x000051b2,0x00005162
.long 0x0000462c,0x0000462c,0x0000484c,0x0000484c,0x00005382,0x00005342,0x00005162,0x00005122
.long 0x00004dfc,0x00004dfc,0x0000501c,0x0000501c,0x00005342,0x00004b72,0x00005122,0x00004952
.long 0x00004e3c,0x00004e3c,0x0000505c,0x0000505c,0x00004b72,0x00004b32,0x00004952,0x00004912
.long 0x00004e8c,0x00004e8c,0x000050ac,0x000050ac,0x00004b32,0x00004ae2,0x00004912,0x000048c2
.long 0x00004ecc,0x00004ecc,0x000050ec,0x000050ec,0x00004ae2,0x00004aa2,0x000048c2,0x00004882
.long 0x0000455e,0x0000455e,0x0000477e,0x0000477e,0x00004aa2,0x00005410,0x00004882,0x000051f0
.long 0x0000459e,0x0000459e,0x000047be,0x000047be,0x00005410,0x000053d0,0x000051f0,0x000051b0
.long 0x000045ee,0x000045ee,0x0000480e,0x0000480e,0x000053d0,0x00005380,0x000051b0,0x00005160
.long 0x0000462e,0x0000462e,0x0000484e,0x0000484e,0x00005380,0x00005340,0x00005160,0x00005120
.long 0x00004dfe,0x00004dfe,0x0000501e,0x0000501e,0x00005340,0x00004b70,0x00005120,0x00004950
.long 0x00004e3e,0x00004e3e,0x0000505e,0x0000505e,0x00004b70,0x00004b30,0x00004950,0x00004910
.long 0x00004e8e,0x00004e8e,0x000050ae,0x000050ae,0x00004b30,0x00004ae0,0x00004910,0x000048c0
.long 0x00004ece,0x00004ece,0x000050ee,0x000050ee,0x00004ae0,0x00004aa0,0x000048c0,0x00004880
.section .rodata,"a"
.p2align 6
.amdhsa_kernel interleave_layers__spectral_fnet__moe_arch_mod__prompt_kernel
  .amdhsa_next_free_vgpr 256
  .amdhsa_next_free_sgpr 102
  .amdhsa_accum_offset 256
  .amdhsa_group_segment_fixed_size 0
  .amdhsa_kernarg_size 104
  .amdhsa_user_sgpr_count 2
  .amdhsa_user_sgpr_kernarg_segment_ptr 1
  .amdhsa_system_sgpr_workgroup_id_x 1
.end_amdhsa_kernel
```
